```python
import torch

def _softmax(x, axis=-1):
    return torch.softmax(x, dim=axis)
def _gelu(x):
    return torch.nn.functional.gelu(x, approximate="tanh")
def _silu(x):
    return torch.nn.functional.silu(x)
def _sigmoid(x):
    return torch.sigmoid(x)
def _layernorm(x, axis=-1, eps=1e-5):
    m = x.mean(dim=axis, keepdim=True)
    v = x.var(dim=axis, keepdim=True, unbiased=False)
    return (x - m) / torch.sqrt(v + eps)
def _scatter_add(tgt, idx, src, axis=0):
    return tgt.clone().index_add_(axis, idx, src)
def _segment_sum(src, seg, n):
    out = torch.zeros((n,) + src.shape[1:], dtype=src.dtype)
    return out.index_add_(0, seg, src)
def _pad(x, pw):
    flat = tuple(v for pair in reversed(pw) for v in pair)
    return torch.nn.functional.pad(x, flat)

kernel_name = 'gated_mix__grouped_kv_mqa__grouped_kv_mqa__prompt'

def setup_inputs():

    _w = (lambda a: (lambda t: t.to(torch.bfloat16) if t.is_floating_point() else t)(torch.as_tensor(a)))
    def _A_setup():
        B, S, D, H = 1, 2048, 640, 32
        Dh = D // H
        return {
            "x": _w((lambda *s: torch.randn(*s, dtype=torch.bfloat16) * 0.05)(B, S, D)),
            "wq": _w((lambda *s: torch.randn(*s, dtype=torch.bfloat16) * 0.8)(D, H * Dh)),
            "wk": _w((lambda *s: torch.randn(*s, dtype=torch.bfloat16) * 0.8)(D, Dh)),
            "wv": _w((lambda *s: torch.randn(*s, dtype=torch.bfloat16) * 0.05)(D, Dh)),
            "wo": _w((lambda *s: torch.randn(*s, dtype=torch.bfloat16) * 0.05)(H * Dh, D)),
        }
    _A_in = _A_setup()

    def _B_setup():
        B, S, D, H = 1, 2048, 640, 32
        Dh = D // H
        return {
            "x": _w((lambda *s: torch.randn(*s, dtype=torch.bfloat16) * 0.05)(B, S, D)),
            "wq": _w((lambda *s: torch.randn(*s, dtype=torch.bfloat16) * 0.8)(D, H * Dh)),
            "wk": _w((lambda *s: torch.randn(*s, dtype=torch.bfloat16) * 0.8)(D, Dh)),
            "wv": _w((lambda *s: torch.randn(*s, dtype=torch.bfloat16) * 0.05)(D, Dh)),
            "wo": _w((lambda *s: torch.randn(*s, dtype=torch.bfloat16) * 0.05)(H * Dh, D)),
        }
    _B_in = _B_setup()

    return {
        "A_x": _A_in["x"],
        "A_wq": _A_in["wq"],
        "A_wk": _A_in["wk"],
        "A_wv": _A_in["wv"],
        "A_wo": _A_in["wo"],
        "B_x": _B_in["x"],
        "B_wq": _B_in["wq"],
        "B_wk": _B_in["wk"],
        "B_wv": _B_in["wv"],
        "B_wo": _B_in["wo"],
        "gate_w": _w((lambda *s: torch.randn(*s, dtype=torch.bfloat16) * 0.05)(640) * 16.0),
    }

def reference(A_x, A_wq, A_wk, A_wv, A_wo, B_x, B_wq, B_wk, B_wv, B_wo, gate_w):
    def _A_ref(x, wq, wk, wv, wo):
        B, S, D = x.shape
        H = 32
        Dh = D // H
        q = (lambda x, *d: x.permute(*d))((x @ wq).reshape(B, S, H, Dh), 0, 2, 1, 3)
        k = x @ wk
        v = x @ wv
        scores = torch.einsum("bhqd,bkd->bhqk", q, k) * (Dh ** -0.5)
        p = _softmax(scores, axis=-1)
        o = torch.einsum("bhqk,bkd->bhqd", p, v)
        return (lambda x, *d: x.permute(*d))(o, 0, 2, 1, 3).reshape(B, S, H * Dh) @ wo

    def _B_ref(x, wq, wk, wv, wo):
        B, S, D = x.shape
        H = 32
        Dh = D // H
        q = (lambda x, *d: x.permute(*d))((x @ wq).reshape(B, S, H, Dh), 0, 2, 1, 3)
        k = x @ wk
        v = x @ wv
        scores = torch.einsum("bhqd,bkd->bhqk", q, k) * (Dh ** -0.5)
        p = _softmax(scores, axis=-1)
        o = torch.einsum("bhqk,bkd->bhqd", p, v)
        return (lambda x, *d: x.permute(*d))(o, 0, 2, 1, 3).reshape(B, S, H * Dh) @ wo

    x = A_x
    g = _sigmoid((x * gate_w).sum(-1, keepdims=True))
    a = _A_ref(x, A_wq, A_wk, A_wv, A_wo)
    b = _B_ref(x, B_wq, B_wk, B_wv, B_wo)
    return g * a + (1 - g) * b
```

```asm
; @launch grid=(256,1,1) block=(512,1,1) lds=163840
.amdgcn_target "amdgcn-amd-amdhsa--gfx950"
.text
.globl gated_mix__grouped_kv_mqa__grouped_kv_mqa__prompt_kernel
.p2align 8
.type gated_mix__grouped_kv_mqa__grouped_kv_mqa__prompt_kernel,@function
gated_mix__grouped_kv_mqa__grouped_kv_mqa__prompt_kernel:
    s_cmp_ge_u32 s2, 256
    s_cbranch_scc1 L_end
    s_load_dwordx16 s[36:51], s[0:1], 0
    s_load_dwordx8 s[52:59], s[0:1], 64
    s_load_dwordx4 s[60:63], s[0:1], 96
    s_getpc_b64 s[6:7]
L_pc:
    s_bfe_u32 s33, s2, 0x20003
    s_lshl_b32 s33, s33, 13
    v_lshl_add_u32 v246, v0, 4, s33
    v_min_u32 v246, L_codeend-L_pc-16, v246
    v_mov_b32 v247, s7
    v_add_co_u32 v246, vcc, s6, v246
    s_cmp_lt_u32 s2, 64
    s_cbranch_scc0 L_ncp
    v_addc_co_u32 v247, vcc, 0, v247, vcc
    global_load_dwordx4 v[248:251], v[246:247], off
L_ncp:
    v_lshrrev_b32 v1, 6, v0
    v_and_b32 v2, 63, v0
    s_and_b32 s21, s2, 7
    v_readfirstlane_b32 s20, v1
    s_lshr_b32 s25, s2, 6
    s_lshl_b32 s22, s25, 3
    s_add_u32 s21, s21, s22
    s_bfe_u32 s22, s2, 0x30003
    s_lshr_b32 s23, s22, 2
    s_and_b32 s24, s22, 3
    s_mov_b32 s25, s22
    s_mul_i32 s26, s25, 52
    s_lshr_b32 s26, s26, 8
    s_mul_i32 s26, s26, 5
    s_sub_u32 s25, s25, s26
    v_lshlrev_b32 v1, 4, v2
    s_lshl_b32 s26, s20, 2
    v_lshrrev_b32 v11, 4, v2
    v_add_u32 v11, s26, v11
    v_xor_b32 v12, v11, v2
    v_and_b32 v12, 15, v12
    v_mul_u32_u24 v11, 1280, v11
    v_lshl_add_u32 v10, v12, 4, v11
    s_lshl_b32 s26, s20, 10
    s_mul_i32 s5, s25, 5120
    s_lshl_b32 s3, s25, 8
    s_add_u32 s33, s3, s26
    s_sub_u32 s33, s33, 1024
    v_add_u32 v14, s33, v1
    v_subrev_u32 v15, 1280, v14
    v_min_u32 v14, v14, v15
    s_and_b32 s32, s24, 1
    s_mul_i32 s27, s21, 81920
    s_mul_i32 s33, s32, 40960
    s_add_u32 s27, s27, s33
    s_lshl_b32 s29, s32, 13
    s_add_u32 s29, s29, s26
    s_mov_b32 s14, 2621440
    s_mov_b32 s15, 0x00020000
    s_mov_b32 s66, 25600
    s_mov_b32 s67, 0x00020000
    s_mov_b32 s18, 819200
    s_mov_b32 s19, 0x00020000
    s_mov_b32 s70, 1280
    s_mov_b32 s71, 0x00020000
    v_and_b32 v3, 31, v2
    v_lshrrev_b32 v4, 5, v2
    s_waitcnt lgkmcnt(0)
    s_mov_b32 s12, s36
    s_mov_b32 s13, s37
    s_add_u32 m0, s29, 0
    s_add_u32 s33, s3, s27
    buffer_load_dwordx4 v10, s[12:15], s33 offen lds
    s_add_u32 s3, s3, 256
    s_cmp_eq_u32 s3, 1280
    s_cselect_b32 s3, 0, s3
    s_cmp_eq_u32 s23, 0
    s_cselect_b32 s16, s38, s48
    s_cselect_b32 s17, s39, s49
    s_cselect_b32 s40, s40, s50
    s_cselect_b32 s41, s41, s51
    s_cselect_b32 s42, s42, s52
    s_cselect_b32 s43, s43, s53
    s_cmp_lt_u32 s24, 2
    s_cselect_b32 s64, s40, s42
    s_cselect_b32 s65, s41, s43
    s_mov_b32 s68, s56
    s_mov_b32 s69, s57
    s_add_u32 s31, s26, 0
    s_add_u32 m0, s31, 122880
    s_add_u32 s33, s31, s5
    s_cmp_ge_u32 s33, 25600
    s_cselect_b32 s30, 25600, 0
    s_sub_u32 s33, s33, s30
    buffer_load_dwordx4 v1, s[64:67], s33 offen lds
    s_cmp_ge_u32 s20, 3
    s_cbranch_scc1 L_noopt
    s_cmp_eq_u32 s20, 0
    s_cbranch_scc1 L_opt0
    s_add_u32 m0, s26, 147456
    s_nop 0
    buffer_load_dwordx4 v14, s[68:71], 0 offen lds
    s_branch L_noopt
L_opt0:
    s_movk_i32 s31, 24576
    s_add_u32 m0, s31, 122880
    s_add_u32 s33, s31, s5
    s_cmp_ge_u32 s33, 25600
    s_cselect_b32 s30, 25600, 0
    s_sub_u32 s33, s33, s30
    buffer_load_dwordx4 v1, s[64:67], s33 offen lds
L_noopt:
    s_add_u32 m0, s29, 16384
    s_add_u32 s33, s3, s27
    buffer_load_dwordx4 v10, s[12:15], s33 offen lds
    s_add_u32 s3, s3, 256
    s_cmp_eq_u32 s3, 1280
    s_cselect_b32 s3, 0, s3
    s_add_u32 s31, s26, 8192
    s_add_u32 m0, s31, 122880
    s_add_u32 s33, s31, s5
    s_cmp_ge_u32 s33, 25600
    s_cselect_b32 s30, 25600, 0
    s_sub_u32 s33, s33, s30
    buffer_load_dwordx4 v1, s[64:67], s33 offen lds
    s_add_u32 m0, s29, 32768
    s_add_u32 s33, s3, s27
    buffer_load_dwordx4 v10, s[12:15], s33 offen lds
    s_add_u32 s3, s3, 256
    s_cmp_eq_u32 s3, 1280
    s_cselect_b32 s3, 0, s3
    s_mov_b32 s8, s62
    s_mov_b32 s9, s63
    s_mov_b32 s10, 7274496
    s_mov_b32 s11, 0x00020000
    s_mov_b32 s72, s60
    s_mov_b32 s73, s61
    s_mov_b32 s74, 256
    s_mov_b32 s75, 0x00020000
    s_lshl_b32 s51, s23, 11
    s_add_u32 s51, s51, 376832
    s_cmp_lg_u32 s20, 4
    s_cbranch_scc1 L_nsnap
    buffer_load_dword v252, v1, s[8:11], s51 offen sc1
    buffer_load_dword v253, v1, s[8:11], s51 offen offset:1024 sc1
L_nsnap:
    s_and_b32 s46, s20, 3
    s_lshr_b32 s47, s20, 2
    s_xor_b32 s47, s47, s32
    v_lshrrev_b32 v12, 2, v2
    v_mul_u32_u24 v12, 1280, v12
    v_and_b32 v13, 3, v2
    v_lshl_add_u32 v5, v13, 4, v12
    s_mul_i32 s33, s46, 20480
    s_mul_i32 s34, s24, 320
    s_add_u32 s35, s33, s34
    s_lshl_b32 s53, s25, 1
    s_lshr_b32 s56, s2, 6
    s_and_b32 s57, s56, 1
    s_mul_i32 s28, s46, 5120
    s_lshl_b32 s33, s47, 13
    v_and_b32 v14, 15, v3
    v_lshlrev_b32 v15, 8, v3
    v_add_u32 v15, s33, v15
    v_xor_b32 v11, v4, v14
    v_lshl_add_u32 v144, v11, 4, v15
    v_xor_b32 v145, 32, v144
    v_xor_b32 v146, 64, v144
    v_xor_b32 v147, 96, v144
    v_xor_b32 v148, 128, v144
    v_xor_b32 v149, 160, v144
    v_xor_b32 v150, 192, v144
    v_xor_b32 v151, 224, v144
    s_lshl_b32 s33, s46, 5
    s_lshl_b32 s30, s57, 7
    s_or_b32 s33, s33, s30
    v_xor_b32 v144, s33, v144
    v_xor_b32 v145, s33, v145
    v_xor_b32 v146, s33, v146
    v_xor_b32 v147, s33, v147
    v_xor_b32 v148, s33, v148
    v_xor_b32 v149, s33, v149
    v_xor_b32 v150, s33, v150
    v_xor_b32 v151, s33, v151
    v_lshlrev_b32 v11, 9, v4
    v_bfe_u32 v12, v2, 2, 2
    v_lshl_add_u32 v11, v12, 6, v11
    v_add_u32 v11, 81920, v11
    v_and_b32 v13, 1, v2
    v_lshlrev_b32 v12, 4, v13
    v_bfe_u32 v14, v2, 1, 1
    v_lshl_add_u32 v12, v14, 3, v12
    v_bfe_u32 v14, v2, 4, 1
    v_mad_u32_u24 v12, v14, 40, v12
    s_mul_i32 s33, s46, 80
    v_add_u32 v12, s33, v12
    v_lshrrev_b32 v15, 6, v12
    v_and_b32 v12, 63, v12
    v_lshl_add_u32 v12, v15, 10, v12
    v_add_u32 v12, v11, v12
    v_xor_b32 v14, v13, v14
    v_lshl_add_u32 v11, v14, 18, v11
    v_bfe_u32 v13, v2, 1, 1
    v_mul_u32_u24 v13, 40, v13
    v_add3_u32 v13, v13, 32, s33
    v_lshrrev_b32 v15, 6, v13
    v_and_b32 v13, 63, v13
    v_lshl_add_u32 v13, v15, 10, v13
    v_add_u32 v153, v11, v13
    s_xor_b32 s33, s46, 0
    s_mul_i32 s33, s33, 5120
    v_add_u32 v192, s33, v12
    s_xor_b32 s33, s46, 1
    s_mul_i32 s33, s33, 5120
    v_add_u32 v193, s33, v12
    s_xor_b32 s33, s46, 2
    s_mul_i32 s33, s33, 5120
    v_add_u32 v194, s33, v12
    s_xor_b32 s33, s46, 3
    s_mul_i32 s33, s33, 5120
    v_add_u32 v195, s33, v12
    v_and_b32 v206, 15, v2
    v_lshrrev_b32 v207, 4, v2
    s_lshl_b32 s32, s32, 1
    s_and_b32 s33, s20, 1
    s_add_u32 s32, s32, s33
    s_lshl_b32 s33, s32, 12
    v_lshlrev_b32 v11, 8, v206
    v_add_u32 v11, s33, v11
    v_xor_b32 v12, v207, v206
    v_lshl_add_u32 v200, v12, 4, v11
    v_xor_b32 v201, 64, v200
    v_xor_b32 v202, 128, v200
    v_xor_b32 v203, 192, v200
    v_lshrrev_b32 v11, 2, v206
    v_lshl_add_u32 v11, v207, 3, v11
    v_mul_u32_u24 v11, 40, v11
    v_and_b32 v12, 3, v206
    v_lshlrev_b32 v12, 3, v12
    s_bitcmp1_b32 s20, 1
    s_cbranch_scc0 L_kvc0
    v_mov_b32 v12, 32
L_kvc0:
    s_mov_b32 s33, 122880
    v_add3_u32 v204, v11, v12, s33
    v_lshlrev_b32 v205, 4, v207
    v_add_u32 v205, 148480, v205
    s_lshl_b32 s32, s32, 4
    s_lshl_b32 s33, s21, 6
    s_add_u32 s32, s32, s33
    v_mov_b32 v208, 0
    v_mov_b32 v209, 0
    v_mov_b32 v210, 0
    v_mov_b32 v211, 0
    v_mov_b32 v212, 0
    v_mov_b32 v213, 0
    v_mov_b32 v214, 0
    v_mov_b32 v215, 0
    s_barrier
    s_add_u32 s31, s26, 16384
    s_add_u32 m0, s31, 122880
    s_add_u32 s33, s31, s5
    s_cmp_ge_u32 s33, 25600
    s_cselect_b32 s30, 25600, 0
    s_sub_u32 s33, s33, s30
    buffer_load_dwordx4 v1, s[64:67], s33 offen lds
    s_add_u32 m0, s29, 49152
    s_add_u32 s33, s3, s27
    buffer_load_dwordx4 v10, s[12:15], s33 offen lds
    s_add_u32 s3, s3, 256
    s_cmp_eq_u32 s3, 1280
    s_cselect_b32 s3, 0, s3
    s_add_u32 m0, s29, 65536
    s_add_u32 s33, s3, s27
    buffer_load_dwordx4 v10, s[12:15], s33 offen lds
    s_add_u32 s3, s3, 256
    s_cmp_eq_u32 s3, 1280
    s_cselect_b32 s3, 0, s3
    s_xor_b32 s29, s29, 8192
    s_bitcmp1_b32 s24, 0
    s_cselect_b32 s33, 4294926336, 0
    s_cselect_b32 s30, 0, 40960
    s_add_u32 s27, s27, s33
    s_add_u32 s27, s27, s30
    v_mov_b32 v16, 0
    v_mov_b32 v17, 0
    v_mov_b32 v18, 0
    v_mov_b32 v19, 0
    v_mov_b32 v20, 0
    v_mov_b32 v21, 0
    v_mov_b32 v22, 0
    v_mov_b32 v23, 0
    v_mov_b32 v24, 0
    v_mov_b32 v25, 0
    v_mov_b32 v26, 0
    v_mov_b32 v27, 0
    v_mov_b32 v28, 0
    v_mov_b32 v29, 0
    v_mov_b32 v30, 0
    v_mov_b32 v31, 0
    v_mov_b32 v32, 0
    v_mov_b32 v33, 0
    v_mov_b32 v34, 0
    v_mov_b32 v35, 0
    v_mov_b32 v188, v1
    v_mov_b32 v154, 0xdddddddd
    v_mul_u32_u24 v189, 320, v4
    v_lshl_add_u32 v189, v3, 4, v189
    v_and_b32 v11, 27, v3
    v_cmp_eq_u32 vcc, 24, v11
    v_mov_b32 v13, 0x3f803f80
    v_lshlrev_b32 v191, 2, v3
    v_cndmask_b32 v13, 0, v13, vcc
    v_mov_b32 v172, v13
    v_mov_b32 v173, v13
    v_mov_b32 v174, v13
    v_mov_b32 v175, v13
    v_mov_b32 v176, v13
    v_mov_b32 v177, v13
    v_mov_b32 v178, v13
    v_mov_b32 v179, v13
    v_mov_b32 v180, v13
    v_mov_b32 v181, v13
    v_mov_b32 v182, v13
    v_mov_b32 v183, v13
    v_mov_b32 v184, v13
    v_mov_b32 v185, v13
    v_mov_b32 v186, v13
    v_mov_b32 v187, v13
    s_barrier
    s_add_u32 m0, s29, 0
    s_add_u32 s33, s3, s27
    buffer_load_dwordx4 v10, s[12:15], s33 offen lds
    s_add_u32 s3, s3, 256
    s_cmp_eq_u32 s3, 1280
    s_cselect_b32 s3, 0, s3
    s_add_u32 m0, s29, 16384
    s_add_u32 s33, s3, s27
    buffer_load_dwordx4 v10, s[12:15], s33 offen lds
    s_add_u32 s3, s3, 256
    s_cmp_eq_u32 s3, 1280
    s_cselect_b32 s3, 0, s3
    s_add_u32 m0, s29, 32768
    s_add_u32 s33, s3, s27
    buffer_load_dwordx4 v10, s[12:15], s33 offen lds
    s_add_u32 s3, s3, 256
    s_cmp_eq_u32 s3, 1280
    s_cselect_b32 s3, 0, s3
    s_add_u32 m0, s29, 49152
    s_add_u32 s33, s3, s27
    buffer_load_dwordx4 v10, s[12:15], s33 offen lds
    s_add_u32 s3, s3, 256
    s_cmp_eq_u32 s3, 1280
    s_cselect_b32 s3, 0, s3
    s_add_u32 m0, s29, 65536
    s_add_u32 s33, s3, s27
    buffer_load_dwordx4 v10, s[12:15], s33 offen lds
    s_add_u32 s3, s3, 256
    s_cmp_eq_u32 s3, 1280
    s_cselect_b32 s3, 0, s3
    s_lshr_b32 s30, s32, 7
    s_mul_i32 s30, s30, 10240
    s_mul_i32 s26, s23, 163840
    s_add_u32 s30, s30, s26
    s_lshr_b32 s3, s2, 6
    s_lshl_b32 s3, s3, 2
    s_add_u32 s3, s3, s24
    s_mul_i32 s3, s3, 11
    s_lshr_b32 s3, s3, 4
    s_mul_i32 s3, s3, 10240
    s_lshl_b32 s27, s22, 3
    s_add_u32 s27, s27, s20
    s_mul_i32 s27, s27, 25600
    s_add_u32 s27, s27, 5636096
    s_movk_i32 s29, 10240
    s_lshl_b32 s50, s21, 2
    s_add_u32 s50, s50, s24
    s_waitcnt vmcnt(5)
    s_barrier
    s_cmp_lt_u32 s20, 4
    s_cbranch_scc1 L_oload
    s_setprio 1
    s_cmp_ge_u32 s24, 2
    s_cbranch_scc1 L_kvV
    ds_read_b128 v[112:115], v200 offset:0
    ds_read_b64_tr_b16 v[120:121], v204 offset:0
    ds_read_b64_tr_b16 v[122:123], v204 offset:160
    ds_read_b128 v[116:119], v201 offset:0
    ds_read_b64_tr_b16 v[124:125], v204 offset:1280
    ds_read_b64_tr_b16 v[126:127], v204 offset:1440
    ds_read_b128 v[216:219], v202 offset:0
    ds_read_b64_tr_b16 v[224:225], v204 offset:2560
    ds_read_b64_tr_b16 v[226:227], v204 offset:2720
    ds_read_b128 v[220:223], v203 offset:0
    ds_read_b64_tr_b16 v[228:229], v204 offset:3840
    ds_read_b64_tr_b16 v[230:231], v204 offset:4000
    s_waitcnt lgkmcnt(6)
    v_mfma_f32_16x16x32_bf16 v[208:211], v[120:123], v[112:115], v[208:211]
    v_mfma_f32_16x16x32_bf16 v[208:211], v[124:127], v[116:119], v[208:211]
    ds_read_b128 v[112:115], v200 offset:16384
    ds_read_b64_tr_b16 v[120:121], v204 offset:5120
    ds_read_b64_tr_b16 v[122:123], v204 offset:5280
    ds_read_b128 v[116:119], v201 offset:16384
    ds_read_b64_tr_b16 v[124:125], v204 offset:6400
    ds_read_b64_tr_b16 v[126:127], v204 offset:6560
    s_waitcnt lgkmcnt(6)
    v_mfma_f32_16x16x32_bf16 v[208:211], v[224:227], v[216:219], v[208:211]
    v_mfma_f32_16x16x32_bf16 v[208:211], v[228:231], v[220:223], v[208:211]
    ds_read_b128 v[216:219], v202 offset:16384
    ds_read_b64_tr_b16 v[224:225], v204 offset:7680
    ds_read_b64_tr_b16 v[226:227], v204 offset:7840
    ds_read_b128 v[220:223], v203 offset:16384
    ds_read_b64_tr_b16 v[228:229], v204 offset:8960
    ds_read_b64_tr_b16 v[230:231], v204 offset:9120
    s_waitcnt lgkmcnt(6)
    v_mfma_f32_16x16x32_bf16 v[208:211], v[120:123], v[112:115], v[208:211]
    v_mfma_f32_16x16x32_bf16 v[208:211], v[124:127], v[116:119], v[208:211]
    ds_read_b128 v[112:115], v200 offset:32768
    ds_read_b64_tr_b16 v[120:121], v204 offset:10240
    ds_read_b64_tr_b16 v[122:123], v204 offset:10400
    ds_read_b128 v[116:119], v201 offset:32768
    ds_read_b64_tr_b16 v[124:125], v204 offset:11520
    ds_read_b64_tr_b16 v[126:127], v204 offset:11680
    s_waitcnt lgkmcnt(6)
    v_mfma_f32_16x16x32_bf16 v[208:211], v[224:227], v[216:219], v[208:211]
    v_mfma_f32_16x16x32_bf16 v[208:211], v[228:231], v[220:223], v[208:211]
    ds_read_b128 v[216:219], v202 offset:32768
    ds_read_b64_tr_b16 v[224:225], v204 offset:12800
    ds_read_b64_tr_b16 v[226:227], v204 offset:12960
    ds_read_b128 v[220:223], v203 offset:32768
    ds_read_b64_tr_b16 v[228:229], v204 offset:14080
    ds_read_b64_tr_b16 v[230:231], v204 offset:14240
    s_waitcnt lgkmcnt(6)
    v_mfma_f32_16x16x32_bf16 v[208:211], v[120:123], v[112:115], v[208:211]
    v_mfma_f32_16x16x32_bf16 v[208:211], v[124:127], v[116:119], v[208:211]
    ds_read_b128 v[112:115], v200 offset:49152
    ds_read_b64_tr_b16 v[120:121], v204 offset:15360
    ds_read_b64_tr_b16 v[122:123], v204 offset:15520
    ds_read_b128 v[116:119], v201 offset:49152
    ds_read_b64_tr_b16 v[124:125], v204 offset:16640
    ds_read_b64_tr_b16 v[126:127], v204 offset:16800
    s_waitcnt lgkmcnt(6)
    v_mfma_f32_16x16x32_bf16 v[208:211], v[224:227], v[216:219], v[208:211]
    v_mfma_f32_16x16x32_bf16 v[208:211], v[228:231], v[220:223], v[208:211]
    ds_read_b128 v[216:219], v202 offset:49152
    ds_read_b64_tr_b16 v[224:225], v204 offset:17920
    ds_read_b64_tr_b16 v[226:227], v204 offset:18080
    ds_read_b128 v[220:223], v203 offset:49152
    ds_read_b64_tr_b16 v[228:229], v204 offset:19200
    ds_read_b64_tr_b16 v[230:231], v204 offset:19360
    s_waitcnt lgkmcnt(6)
    v_mfma_f32_16x16x32_bf16 v[208:211], v[120:123], v[112:115], v[208:211]
    v_mfma_f32_16x16x32_bf16 v[208:211], v[124:127], v[116:119], v[208:211]
    v_add_u32 v200, 0x10000, v200
    v_add_u32 v201, 0x10000, v201
    v_add_u32 v202, 0x10000, v202
    v_add_u32 v203, 0x10000, v203
    ds_read_b128 v[112:115], v200 offset:0
    ds_read_b64_tr_b16 v[120:121], v204 offset:20480
    ds_read_b64_tr_b16 v[122:123], v204 offset:20640
    ds_read_b128 v[116:119], v201 offset:0
    ds_read_b64_tr_b16 v[124:125], v204 offset:21760
    ds_read_b64_tr_b16 v[126:127], v204 offset:21920
    s_waitcnt lgkmcnt(6)
    v_mfma_f32_16x16x32_bf16 v[208:211], v[224:227], v[216:219], v[208:211]
    v_mfma_f32_16x16x32_bf16 v[208:211], v[228:231], v[220:223], v[208:211]
    ds_read_b128 v[216:219], v202 offset:0
    ds_read_b64_tr_b16 v[224:225], v204 offset:23040
    ds_read_b64_tr_b16 v[226:227], v204 offset:23200
    ds_read_b128 v[220:223], v203 offset:0
    ds_read_b64_tr_b16 v[228:229], v204 offset:24320
    ds_read_b64_tr_b16 v[230:231], v204 offset:24480
    s_waitcnt lgkmcnt(6)
    v_mfma_f32_16x16x32_bf16 v[208:211], v[120:123], v[112:115], v[208:211]
    v_mfma_f32_16x16x32_bf16 v[208:211], v[124:127], v[116:119], v[208:211]
    s_waitcnt lgkmcnt(0)
    v_mfma_f32_16x16x32_bf16 v[208:211], v[224:227], v[216:219], v[208:211]
    v_mfma_f32_16x16x32_bf16 v[208:211], v[228:231], v[220:223], v[208:211]
    s_mov_b32 s33, 1051011932
    s_waitcnt vmcnt(0)
    s_nop 6
    v_mul_f32 v208, s33, v208
    v_mul_f32 v209, s33, v209
    v_mul_f32 v210, s33, v210
    v_mul_f32 v211, s33, v211
    v_cvt_pk_bf16_f32 v240, v208, v209
    v_cvt_pk_bf16_f32 v241, v210, v211
    v_mul_f32 v242, v208, v208
    v_fmac_f32 v242, v209, v209
    v_fmac_f32 v242, v210, v210
    v_fmac_f32 v242, v211, v211
    s_bitcmp1_b32 s20, 1
    s_cbranch_scc1 L_kvK4
    s_bfe_u32 s31, s32, 0x20005
    s_lshl_b32 s31, s31, 10
    s_add_u32 s30, s30, s31
    s_and_b32 s31, s32, 31
    s_lshl_b32 s31, s31, 4
    s_add_u32 s30, s30, s31
    v_mov_b32 v248, v240
    v_mov_b32 v249, v241
    v_mov_b32 v250, v240
    v_mov_b32 v251, v241
    v_lshrrev_b32 v243, 1, v207
    v_lshlrev_b32 v243, 9, v243
    v_permlane16_swap_b32 v248, v250
    v_permlane16_swap_b32 v249, v251
    v_lshl_add_u32 v243, v206, 4, v243
    s_mov_b32 exec_lo, 0xffff
    s_mov_b32 exec_hi, 0xffff
    buffer_store_dwordx4 v[248:251], v243, s[8:11], s30 offen sc1
    s_mov_b64 exec, -1
    v_mov_b32 v244, v242
    s_nop 1
    v_permlane16_swap_b32 v242, v244
    v_add_f32 v242, v242, v244
    v_mov_b32 v244, v242
    s_nop 1
    v_permlane32_swap_b32 v242, v244
    v_add_f32 v242, v242, v244
    s_mov_b32 s30, 0
    s_branch L_kvmax
L_kvK4:
    s_and_b32 s31, s32, 63
    s_lshl_b32 s31, s31, 4
    s_add_u32 s30, s30, s31
    s_bfe_u32 s31, s32, 0x10006
    s_lshl_b32 s31, s31, 3
    s_add_u32 s30, s30, s31
    s_add_u32 s30, s30, 4096
    v_lshlrev_b32 v243, 4, v206
    s_mov_b64 exec, 0xffff
    buffer_store_dwordx2 v[240:241], v243, s[8:11], s30 offen sc1
    s_mov_b64 exec, -1
    s_movk_i32 s30, 512
L_kvmax:
    s_nop 1
    v_max_f32_dpp v242, v242, v242 row_ror:8 row_mask:0xf bank_mask:0xf
    s_nop 1
    v_max_f32_dpp v242, v242, v242 row_ror:4 row_mask:0xf bank_mask:0xf
    s_nop 1
    v_max_f32_dpp v242, v242, v242 row_ror:2 row_mask:0xf bank_mask:0xf
    s_nop 1
    v_max_f32_dpp v242, v242, v242 row_ror:1 row_mask:0xf bank_mask:0xf
    s_lshl_b32 s31, s23, 10
    s_add_u32 s31, s31, s30
    s_lshr_b32 s30, s32, 4
    s_lshl_b32 s30, s30, 2
    s_add_u32 s31, s31, s30
    s_add_u32 s31, s31, 327680
    v_mov_b32 v243, 0
    s_mov_b64 exec, 1
    buffer_store_dword v242, v243, s[8:11], s31 offen sc1
    s_branch L_kvend
L_kvV:
    s_bitcmp1_b32 s20, 1
    s_cbranch_scc1 L_kvG
    ds_read_b128 v[112:115], v200 offset:0
    ds_read_b64_tr_b16 v[120:121], v204 offset:0
    ds_read_b64_tr_b16 v[122:123], v204 offset:160
    ds_read_b128 v[116:119], v201 offset:0
    ds_read_b64_tr_b16 v[124:125], v204 offset:1280
    ds_read_b64_tr_b16 v[126:127], v204 offset:1440
    ds_read_b128 v[216:219], v202 offset:0
    ds_read_b64_tr_b16 v[224:225], v204 offset:2560
    ds_read_b64_tr_b16 v[226:227], v204 offset:2720
    ds_read_b128 v[220:223], v203 offset:0
    ds_read_b64_tr_b16 v[228:229], v204 offset:3840
    ds_read_b64_tr_b16 v[230:231], v204 offset:4000
    s_waitcnt lgkmcnt(6)
    v_mfma_f32_16x16x32_bf16 v[208:211], v[112:115], v[120:123], v[208:211]
    v_mfma_f32_16x16x32_bf16 v[208:211], v[116:119], v[124:127], v[208:211]
    ds_read_b128 v[112:115], v200 offset:16384
    ds_read_b64_tr_b16 v[120:121], v204 offset:5120
    ds_read_b64_tr_b16 v[122:123], v204 offset:5280
    ds_read_b128 v[116:119], v201 offset:16384
    ds_read_b64_tr_b16 v[124:125], v204 offset:6400
    ds_read_b64_tr_b16 v[126:127], v204 offset:6560
    s_waitcnt lgkmcnt(6)
    v_mfma_f32_16x16x32_bf16 v[208:211], v[216:219], v[224:227], v[208:211]
    v_mfma_f32_16x16x32_bf16 v[208:211], v[220:223], v[228:231], v[208:211]
    ds_read_b128 v[216:219], v202 offset:16384
    ds_read_b64_tr_b16 v[224:225], v204 offset:7680
    ds_read_b64_tr_b16 v[226:227], v204 offset:7840
    ds_read_b128 v[220:223], v203 offset:16384
    ds_read_b64_tr_b16 v[228:229], v204 offset:8960
    ds_read_b64_tr_b16 v[230:231], v204 offset:9120
    s_waitcnt lgkmcnt(6)
    v_mfma_f32_16x16x32_bf16 v[208:211], v[112:115], v[120:123], v[208:211]
    v_mfma_f32_16x16x32_bf16 v[208:211], v[116:119], v[124:127], v[208:211]
    ds_read_b128 v[112:115], v200 offset:32768
    ds_read_b64_tr_b16 v[120:121], v204 offset:10240
    ds_read_b64_tr_b16 v[122:123], v204 offset:10400
    ds_read_b128 v[116:119], v201 offset:32768
    ds_read_b64_tr_b16 v[124:125], v204 offset:11520
    ds_read_b64_tr_b16 v[126:127], v204 offset:11680
    s_waitcnt lgkmcnt(6)
    v_mfma_f32_16x16x32_bf16 v[208:211], v[216:219], v[224:227], v[208:211]
    v_mfma_f32_16x16x32_bf16 v[208:211], v[220:223], v[228:231], v[208:211]
    ds_read_b128 v[216:219], v202 offset:32768
    ds_read_b64_tr_b16 v[224:225], v204 offset:12800
    ds_read_b64_tr_b16 v[226:227], v204 offset:12960
    ds_read_b128 v[220:223], v203 offset:32768
    ds_read_b64_tr_b16 v[228:229], v204 offset:14080
    ds_read_b64_tr_b16 v[230:231], v204 offset:14240
    s_waitcnt lgkmcnt(6)
    v_mfma_f32_16x16x32_bf16 v[208:211], v[112:115], v[120:123], v[208:211]
    v_mfma_f32_16x16x32_bf16 v[208:211], v[116:119], v[124:127], v[208:211]
    ds_read_b128 v[112:115], v200 offset:49152
    ds_read_b64_tr_b16 v[120:121], v204 offset:15360
    ds_read_b64_tr_b16 v[122:123], v204 offset:15520
    ds_read_b128 v[116:119], v201 offset:49152
    ds_read_b64_tr_b16 v[124:125], v204 offset:16640
    ds_read_b64_tr_b16 v[126:127], v204 offset:16800
    s_waitcnt lgkmcnt(6)
    v_mfma_f32_16x16x32_bf16 v[208:211], v[216:219], v[224:227], v[208:211]
    v_mfma_f32_16x16x32_bf16 v[208:211], v[220:223], v[228:231], v[208:211]
    ds_read_b128 v[216:219], v202 offset:49152
    ds_read_b64_tr_b16 v[224:225], v204 offset:17920
    ds_read_b64_tr_b16 v[226:227], v204 offset:18080
    ds_read_b128 v[220:223], v203 offset:49152
    ds_read_b64_tr_b16 v[228:229], v204 offset:19200
    ds_read_b64_tr_b16 v[230:231], v204 offset:19360
    s_waitcnt lgkmcnt(6)
    v_mfma_f32_16x16x32_bf16 v[208:211], v[112:115], v[120:123], v[208:211]
    v_mfma_f32_16x16x32_bf16 v[208:211], v[116:119], v[124:127], v[208:211]
    v_add_u32 v200, 0x10000, v200
    v_add_u32 v201, 0x10000, v201
    v_add_u32 v202, 0x10000, v202
    v_add_u32 v203, 0x10000, v203
    ds_read_b128 v[112:115], v200 offset:0
    ds_read_b64_tr_b16 v[120:121], v204 offset:20480
    ds_read_b64_tr_b16 v[122:123], v204 offset:20640
    ds_read_b128 v[116:119], v201 offset:0
    ds_read_b64_tr_b16 v[124:125], v204 offset:21760
    ds_read_b64_tr_b16 v[126:127], v204 offset:21920
    s_waitcnt lgkmcnt(6)
    v_mfma_f32_16x16x32_bf16 v[208:211], v[216:219], v[224:227], v[208:211]
    v_mfma_f32_16x16x32_bf16 v[208:211], v[220:223], v[228:231], v[208:211]
    ds_read_b128 v[216:219], v202 offset:0
    ds_read_b64_tr_b16 v[224:225], v204 offset:23040
    ds_read_b64_tr_b16 v[226:227], v204 offset:23200
    ds_read_b128 v[220:223], v203 offset:0
    ds_read_b64_tr_b16 v[228:229], v204 offset:24320
    ds_read_b64_tr_b16 v[230:231], v204 offset:24480
    s_waitcnt lgkmcnt(6)
    v_mfma_f32_16x16x32_bf16 v[208:211], v[112:115], v[120:123], v[208:211]
    v_mfma_f32_16x16x32_bf16 v[208:211], v[116:119], v[124:127], v[208:211]
    s_waitcnt lgkmcnt(0)
    v_mfma_f32_16x16x32_bf16 v[208:211], v[216:219], v[224:227], v[208:211]
    v_mfma_f32_16x16x32_bf16 v[208:211], v[220:223], v[228:231], v[208:211]
    s_branch L_kvV2
L_kvG:
    ds_read_b128 v[112:115], v200 offset:0
    ds_read_b64_tr_b16 v[120:121], v204 offset:0
    ds_read_b64_tr_b16 v[122:123], v204 offset:160
    ds_read_b128 v[128:131], v205 offset:0
    ds_read_b128 v[116:119], v201 offset:0
    ds_read_b64_tr_b16 v[124:125], v204 offset:1280
    ds_read_b64_tr_b16 v[126:127], v204 offset:1440
    ds_read_b128 v[132:135], v205 offset:64
    s_waitcnt lgkmcnt(7)
    ds_read_b128 v[216:219], v202 offset:0
    ds_read_b64_tr_b16 v[224:225], v204 offset:2560
    ds_read_b64_tr_b16 v[226:227], v204 offset:2720
    ds_read_b128 v[232:235], v205 offset:128
    ds_read_b128 v[220:223], v203 offset:0
    ds_read_b64_tr_b16 v[228:229], v204 offset:3840
    ds_read_b64_tr_b16 v[230:231], v204 offset:4000
    ds_read_b128 v[236:239], v205 offset:192
    s_waitcnt lgkmcnt(8)
    v_mfma_f32_16x16x32_bf16 v[208:211], v[112:115], v[120:123], v[208:211]
    v_mfma_f32_16x16x32_bf16 v[212:215], v[112:115], v[128:131], v[212:215]
    v_mfma_f32_16x16x32_bf16 v[208:211], v[116:119], v[124:127], v[208:211]
    v_mfma_f32_16x16x32_bf16 v[212:215], v[116:119], v[132:135], v[212:215]
    s_waitcnt lgkmcnt(7)
    ds_read_b128 v[112:115], v200 offset:16384
    ds_read_b64_tr_b16 v[120:121], v204 offset:5120
    ds_read_b64_tr_b16 v[122:123], v204 offset:5280
    ds_read_b128 v[128:131], v205 offset:256
    ds_read_b128 v[116:119], v201 offset:16384
    ds_read_b64_tr_b16 v[124:125], v204 offset:6400
    ds_read_b64_tr_b16 v[126:127], v204 offset:6560
    ds_read_b128 v[132:135], v205 offset:320
    s_waitcnt lgkmcnt(8)
    v_mfma_f32_16x16x32_bf16 v[208:211], v[216:219], v[224:227], v[208:211]
    v_mfma_f32_16x16x32_bf16 v[212:215], v[216:219], v[232:235], v[212:215]
    v_mfma_f32_16x16x32_bf16 v[208:211], v[220:223], v[228:231], v[208:211]
    v_mfma_f32_16x16x32_bf16 v[212:215], v[220:223], v[236:239], v[212:215]
    s_waitcnt lgkmcnt(7)
    ds_read_b128 v[216:219], v202 offset:16384
    ds_read_b64_tr_b16 v[224:225], v204 offset:7680
    ds_read_b64_tr_b16 v[226:227], v204 offset:7840
    ds_read_b128 v[232:235], v205 offset:384
    ds_read_b128 v[220:223], v203 offset:16384
    ds_read_b64_tr_b16 v[228:229], v204 offset:8960
    ds_read_b64_tr_b16 v[230:231], v204 offset:9120
    ds_read_b128 v[236:239], v205 offset:448
    s_waitcnt lgkmcnt(8)
    v_mfma_f32_16x16x32_bf16 v[208:211], v[112:115], v[120:123], v[208:211]
    v_mfma_f32_16x16x32_bf16 v[212:215], v[112:115], v[128:131], v[212:215]
    v_mfma_f32_16x16x32_bf16 v[208:211], v[116:119], v[124:127], v[208:211]
    v_mfma_f32_16x16x32_bf16 v[212:215], v[116:119], v[132:135], v[212:215]
    s_waitcnt lgkmcnt(7)
    ds_read_b128 v[112:115], v200 offset:32768
    ds_read_b64_tr_b16 v[120:121], v204 offset:10240
    ds_read_b64_tr_b16 v[122:123], v204 offset:10400
    ds_read_b128 v[128:131], v205 offset:512
    ds_read_b128 v[116:119], v201 offset:32768
    ds_read_b64_tr_b16 v[124:125], v204 offset:11520
    ds_read_b64_tr_b16 v[126:127], v204 offset:11680
    ds_read_b128 v[132:135], v205 offset:576
    s_waitcnt lgkmcnt(8)
    v_mfma_f32_16x16x32_bf16 v[208:211], v[216:219], v[224:227], v[208:211]
    v_mfma_f32_16x16x32_bf16 v[212:215], v[216:219], v[232:235], v[212:215]
    v_mfma_f32_16x16x32_bf16 v[208:211], v[220:223], v[228:231], v[208:211]
    v_mfma_f32_16x16x32_bf16 v[212:215], v[220:223], v[236:239], v[212:215]
    s_waitcnt lgkmcnt(7)
    ds_read_b128 v[216:219], v202 offset:32768
    ds_read_b64_tr_b16 v[224:225], v204 offset:12800
    ds_read_b64_tr_b16 v[226:227], v204 offset:12960
    ds_read_b128 v[232:235], v205 offset:640
    ds_read_b128 v[220:223], v203 offset:32768
    ds_read_b64_tr_b16 v[228:229], v204 offset:14080
    ds_read_b64_tr_b16 v[230:231], v204 offset:14240
    ds_read_b128 v[236:239], v205 offset:704
    s_waitcnt lgkmcnt(8)
    v_mfma_f32_16x16x32_bf16 v[208:211], v[112:115], v[120:123], v[208:211]
    v_mfma_f32_16x16x32_bf16 v[212:215], v[112:115], v[128:131], v[212:215]
    v_mfma_f32_16x16x32_bf16 v[208:211], v[116:119], v[124:127], v[208:211]
    v_mfma_f32_16x16x32_bf16 v[212:215], v[116:119], v[132:135], v[212:215]
    s_waitcnt lgkmcnt(7)
    ds_read_b128 v[112:115], v200 offset:49152
    ds_read_b64_tr_b16 v[120:121], v204 offset:15360
    ds_read_b64_tr_b16 v[122:123], v204 offset:15520
    ds_read_b128 v[128:131], v205 offset:768
    ds_read_b128 v[116:119], v201 offset:49152
    ds_read_b64_tr_b16 v[124:125], v204 offset:16640
    ds_read_b64_tr_b16 v[126:127], v204 offset:16800
    ds_read_b128 v[132:135], v205 offset:832
    s_waitcnt lgkmcnt(8)
    v_mfma_f32_16x16x32_bf16 v[208:211], v[216:219], v[224:227], v[208:211]
    v_mfma_f32_16x16x32_bf16 v[212:215], v[216:219], v[232:235], v[212:215]
    v_mfma_f32_16x16x32_bf16 v[208:211], v[220:223], v[228:231], v[208:211]
    v_mfma_f32_16x16x32_bf16 v[212:215], v[220:223], v[236:239], v[212:215]
    s_waitcnt lgkmcnt(7)
    ds_read_b128 v[216:219], v202 offset:49152
    ds_read_b64_tr_b16 v[224:225], v204 offset:17920
    ds_read_b64_tr_b16 v[226:227], v204 offset:18080
    ds_read_b128 v[232:235], v205 offset:896
    ds_read_b128 v[220:223], v203 offset:49152
    ds_read_b64_tr_b16 v[228:229], v204 offset:19200
    ds_read_b64_tr_b16 v[230:231], v204 offset:19360
    ds_read_b128 v[236:239], v205 offset:960
    s_waitcnt lgkmcnt(8)
    v_mfma_f32_16x16x32_bf16 v[208:211], v[112:115], v[120:123], v[208:211]
    v_mfma_f32_16x16x32_bf16 v[212:215], v[112:115], v[128:131], v[212:215]
    v_mfma_f32_16x16x32_bf16 v[208:211], v[116:119], v[124:127], v[208:211]
    v_mfma_f32_16x16x32_bf16 v[212:215], v[116:119], v[132:135], v[212:215]
    s_waitcnt lgkmcnt(7)
    v_add_u32 v200, 0x10000, v200
    v_add_u32 v201, 0x10000, v201
    v_add_u32 v202, 0x10000, v202
    v_add_u32 v203, 0x10000, v203
    ds_read_b128 v[112:115], v200 offset:0
    ds_read_b64_tr_b16 v[120:121], v204 offset:20480
    ds_read_b64_tr_b16 v[122:123], v204 offset:20640
    ds_read_b128 v[128:131], v205 offset:1024
    ds_read_b128 v[116:119], v201 offset:0
    ds_read_b64_tr_b16 v[124:125], v204 offset:21760
    ds_read_b64_tr_b16 v[126:127], v204 offset:21920
    ds_read_b128 v[132:135], v205 offset:1088
    s_waitcnt lgkmcnt(8)
    v_mfma_f32_16x16x32_bf16 v[208:211], v[216:219], v[224:227], v[208:211]
    v_mfma_f32_16x16x32_bf16 v[212:215], v[216:219], v[232:235], v[212:215]
    v_mfma_f32_16x16x32_bf16 v[208:211], v[220:223], v[228:231], v[208:211]
    v_mfma_f32_16x16x32_bf16 v[212:215], v[220:223], v[236:239], v[212:215]
    s_waitcnt lgkmcnt(7)
    ds_read_b128 v[216:219], v202 offset:0
    ds_read_b64_tr_b16 v[224:225], v204 offset:23040
    ds_read_b64_tr_b16 v[226:227], v204 offset:23200
    ds_read_b128 v[232:235], v205 offset:1152
    ds_read_b128 v[220:223], v203 offset:0
    ds_read_b64_tr_b16 v[228:229], v204 offset:24320
    ds_read_b64_tr_b16 v[230:231], v204 offset:24480
    ds_read_b128 v[236:239], v205 offset:1216
    s_waitcnt lgkmcnt(8)
    v_mfma_f32_16x16x32_bf16 v[208:211], v[112:115], v[120:123], v[208:211]
    v_mfma_f32_16x16x32_bf16 v[212:215], v[112:115], v[128:131], v[212:215]
    v_mfma_f32_16x16x32_bf16 v[208:211], v[116:119], v[124:127], v[208:211]
    v_mfma_f32_16x16x32_bf16 v[212:215], v[116:119], v[132:135], v[212:215]
    s_waitcnt lgkmcnt(0)
    v_mfma_f32_16x16x32_bf16 v[208:211], v[216:219], v[224:227], v[208:211]
    v_mfma_f32_16x16x32_bf16 v[212:215], v[216:219], v[232:235], v[212:215]
    v_mfma_f32_16x16x32_bf16 v[208:211], v[220:223], v[228:231], v[208:211]
    v_mfma_f32_16x16x32_bf16 v[212:215], v[220:223], v[236:239], v[212:215]
    s_mov_b32 s33, 1069066811
    s_cmp_eq_u32 s23, 0
    s_cselect_b32 s31, 0x80000000, 0
    s_xor_b32 s33, s33, s31
    s_lshl_b32 s31, s23, 13
    s_lshl_b32 s4, s32, 2
    s_add_u32 s31, s31, s4
    s_add_u32 s31, s31, 331776
    v_mul_f32 v212, s33, v212
    v_mul_f32 v213, s33, v213
    v_mul_f32 v214, s33, v214
    v_mul_f32 v215, s33, v215
    v_exp_f32 v212, v212
    v_exp_f32 v213, v213
    v_exp_f32 v214, v214
    v_exp_f32 v215, v215
    v_add_f32 v212, 1.0, v212
    v_add_f32 v213, 1.0, v213
    v_add_f32 v214, 1.0, v214
    v_add_f32 v215, 1.0, v215
    v_rcp_f32 v212, v212
    v_rcp_f32 v213, v213
    v_rcp_f32 v214, v214
    v_rcp_f32 v215, v215
    v_lshlrev_b32 v243, 4, v207
    s_waitcnt vmcnt(0)
    s_mov_b32 exec_lo, 0x00010001
    s_mov_b32 exec_hi, 0x00010001
    buffer_store_dwordx4 v[212:215], v243, s[8:11], s31 offen sc1
    s_mov_b64 exec, -1
    s_branch L_kvV3
L_kvV2:
    s_waitcnt vmcnt(0)
L_kvV3:
    s_bfe_u32 s31, s32, 0x30004
    s_mul_i32 s31, s31, 640
    s_add_u32 s30, s30, s31
    s_add_u32 s30, s30, 5120
    v_lshrrev_b32 v243, 1, v207
    v_mul_u32_u24 v243, 320, v243
    v_lshl_add_u32 v243, v206, 4, v243
    s_nop 1
    v_cvt_pk_bf16_f32 v248, v208, v209
    v_cvt_pk_bf16_f32 v249, v210, v211
    v_cvt_pk_bf16_f32 v250, v208, v209
    v_cvt_pk_bf16_f32 v251, v210, v211
    s_bitcmp1_b32 s20, 1
    s_cselect_b32 s31, 256, 0
    s_cselect_b32 s33, 15, 0xffff
    v_permlane16_swap_b32 v248, v250
    v_permlane16_swap_b32 v249, v251
    s_add_u32 s30, s30, s31
    s_mov_b32 exec_lo, s33
    s_mov_b32 exec_hi, s33
    buffer_store_dwordx4 v[248:251], v243, s[8:11], s30 offen sc1
L_kvend:
    s_cmp_lg_u32 s20, 4
    s_cbranch_scc1 L_kvnc
    s_lshl_b32 s30, s21, 9
    s_add_u32 s30, s30, 360448
    s_lshl_b32 s31, s22, 5
    s_add_u32 s33, s30, s31
    s_lshl_b32 s31, s22, 2
    s_add_u32 s30, s30, s31
    s_getreg_b32 s31, hwreg(HW_REG_XCC_ID, 0, 4)
    s_mov_b64 exec, 3
    v_mov_b32 v244, s31
    buffer_store_dwordx4 v[16:19], v1, s[8:11], s33 offen offset:256 sc1
    s_mov_b64 exec, 1
    buffer_store_dword v244, v1, s[8:11], s30 offen sc1
L_kvnc:
    s_mov_b64 exec, -1
    s_branch L_q0
L_oload:
    s_xor_b32 s34, s56, 0
    s_add_u32 s34, s34, s53
    s_cmp_ge_u32 s34, 10
    s_cselect_b32 s33, 10, 0
    s_sub_u32 s34, s34, s33
    s_mul_i32 s34, s34, 81920
    s_add_u32 s34, s34, s35
    s_add_u32 m0, s28, 81920
    s_nop 0
    buffer_load_dwordx4 v5, s[16:19], s34 offen offset:0 lds
    s_add_u32 m0, s28, 82880
    s_nop 0
    buffer_load_dwordx4 v5, s[16:19], s34 offen offset:64 lds
    s_add_u32 m0, s28, 83840
    s_nop 0
    buffer_load_dwordx4 v5, s[16:19], s34 offen offset:128 lds
    s_add_u32 m0, s28, 84800
    s_nop 0
    buffer_load_dwordx4 v5, s[16:19], s34 offen offset:192 lds
    s_add_u32 m0, s28, 85760
    s_nop 0
    buffer_load_dwordx4 v5, s[16:19], s34 offen offset:256 lds
    s_xor_b32 s34, s56, 1
    s_add_u32 s34, s34, s53
    s_cmp_ge_u32 s34, 10
    s_cselect_b32 s33, 10, 0
    s_sub_u32 s34, s34, s33
    s_mul_i32 s34, s34, 81920
    s_add_u32 s34, s34, s35
    s_add_u32 m0, s28, 102400
    s_nop 0
    buffer_load_dwordx4 v5, s[16:19], s34 offen offset:0 lds
    s_add_u32 m0, s28, 103360
    s_nop 0
    buffer_load_dwordx4 v5, s[16:19], s34 offen offset:64 lds
    s_add_u32 m0, s28, 104320
    s_nop 0
    buffer_load_dwordx4 v5, s[16:19], s34 offen offset:128 lds
    s_add_u32 m0, s28, 105280
    s_nop 0
    buffer_load_dwordx4 v5, s[16:19], s34 offen offset:192 lds
    s_add_u32 m0, s28, 106240
    s_nop 0
    buffer_load_dwordx4 v5, s[16:19], s34 offen offset:256 lds
    s_lshr_b32 s30, s56, 1
    s_lshl_b32 s30, s30, 14
    s_mov_b32 s33, s30
    v_add_u32 v144, s33, v144
    v_add_u32 v145, s33, v145
    v_add_u32 v146, s33, v146
    v_add_u32 v147, s33, v147
    v_add_u32 v148, s33, v148
    v_add_u32 v149, s33, v149
    v_add_u32 v150, s33, v150
    v_add_u32 v151, s33, v151
    ds_read_b128 v[48:51], v144 offset:0
    ds_read_b128 v[52:55], v145 offset:0
    ds_read_b128 v[56:59], v146 offset:0
    ds_read_b128 v[60:63], v147 offset:0
    ds_read_b128 v[64:67], v148 offset:0
    ds_read_b128 v[68:71], v149 offset:0
    ds_read_b128 v[72:75], v150 offset:0
    ds_read_b128 v[76:79], v151 offset:0
    ds_read_b128 v[112:115], v144 offset:32768
    ds_read_b128 v[116:119], v145 offset:32768
    ds_read_b128 v[120:123], v146 offset:32768
    ds_read_b128 v[124:127], v147 offset:32768
    s_waitcnt lgkmcnt(8)
    ds_read_b128 v[128:131], v148 offset:32768
    ds_read_b128 v[132:135], v149 offset:32768
    ds_read_b128 v[136:139], v150 offset:32768
    ds_read_b128 v[140:143], v151 offset:32768
    s_lshl_b32 s33, s30, 1
    s_sub_u32 s33, 16384, s33
    v_add_u32 v144, s33, v144
    v_add_u32 v145, s33, v145
    v_add_u32 v146, s33, v146
    v_add_u32 v147, s33, v147
    v_add_u32 v148, s33, v148
    v_add_u32 v149, s33, v149
    v_add_u32 v150, s33, v150
    v_add_u32 v151, s33, v151
    s_waitcnt lgkmcnt(4)
    ds_read_b128 v[80:83], v144 offset:0
    ds_read_b128 v[84:87], v145 offset:0
    ds_read_b128 v[88:91], v146 offset:0
    ds_read_b128 v[92:95], v147 offset:0
    ds_read_b128 v[96:99], v148 offset:0
    ds_read_b128 v[100:103], v149 offset:0
    ds_read_b128 v[104:107], v150 offset:0
    ds_read_b128 v[108:111], v151 offset:0
    s_waitcnt lgkmcnt(4)
    s_xor_b32 s33, s46, 0
    s_mul_i32 s33, s33, 5120
    v_add_u32 v244, s33, v153
    s_xor_b32 s33, s46, 1
    s_mul_i32 s33, s33, 5120
    v_add_u32 v245, s33, v153
    s_xor_b32 s33, s46, 2
    s_mul_i32 s33, s33, 5120
    v_add_u32 v246, s33, v153
    s_xor_b32 s33, s46, 3
    s_mul_i32 s33, s33, 5120
    v_add_u32 v247, s33, v153
    s_waitcnt vmcnt(5)
L_q0:
    s_cmp_lt_u32 s20, 4
    s_cselect_b64 vcc, -1, 0
    v_mov_b32 v155, 0
    s_mov_b32 s52, 0
    s_barrier
    s_cbranch_vccnz L_i0o
    s_lshr_b32 s30, s56, 1
    s_lshl_b32 s30, s30, 14
    s_mov_b32 s33, s30
    v_add_u32 v144, s33, v144
    v_add_u32 v145, s33, v145
    v_add_u32 v146, s33, v146
    v_add_u32 v147, s33, v147
    v_add_u32 v148, s33, v148
    v_add_u32 v149, s33, v149
    v_add_u32 v150, s33, v150
    v_add_u32 v151, s33, v151
    ds_read_b128 v[48:51], v144 offset:0
    ds_read_b128 v[52:55], v145 offset:0
    ds_read_b128 v[56:59], v146 offset:0
    ds_read_b128 v[60:63], v147 offset:0
    ds_read_b128 v[64:67], v148 offset:0
    ds_read_b128 v[68:71], v149 offset:0
    ds_read_b128 v[72:75], v150 offset:0
    ds_read_b128 v[76:79], v151 offset:0
    ds_read_b128 v[112:115], v144 offset:32768
    ds_read_b128 v[116:119], v145 offset:32768
    ds_read_b128 v[120:123], v146 offset:32768
    ds_read_b128 v[124:127], v147 offset:32768
    s_waitcnt lgkmcnt(8)
    ds_read_b128 v[128:131], v148 offset:32768
    ds_read_b128 v[132:135], v149 offset:32768
    ds_read_b128 v[136:139], v150 offset:32768
    ds_read_b128 v[140:143], v151 offset:32768
    s_lshl_b32 s33, s30, 1
    s_sub_u32 s33, 16384, s33
    v_add_u32 v144, s33, v144
    v_add_u32 v145, s33, v145
    v_add_u32 v146, s33, v146
    v_add_u32 v147, s33, v147
    v_add_u32 v148, s33, v148
    v_add_u32 v149, s33, v149
    v_add_u32 v150, s33, v150
    v_add_u32 v151, s33, v151
    s_waitcnt lgkmcnt(4)
    ds_read_b128 v[80:83], v144 offset:0
    ds_read_b128 v[84:87], v145 offset:0
    ds_read_b128 v[88:91], v146 offset:0
    ds_read_b128 v[92:95], v147 offset:0
    ds_read_b128 v[96:99], v148 offset:0
    ds_read_b128 v[100:103], v149 offset:0
    ds_read_b128 v[104:107], v150 offset:0
    ds_read_b128 v[108:111], v151 offset:0
    s_waitcnt lgkmcnt(4)
    s_xor_b32 s33, s46, 0
    s_mul_i32 s33, s33, 5120
    v_add_u32 v244, s33, v153
    s_xor_b32 s33, s46, 1
    s_mul_i32 s33, s33, 5120
    v_add_u32 v245, s33, v153
    s_xor_b32 s33, s46, 2
    s_mul_i32 s33, s33, 5120
    v_add_u32 v246, s33, v153
    s_xor_b32 s33, s46, 3
    s_mul_i32 s33, s33, 5120
    v_add_u32 v247, s33, v153
    s_branch L_i0e
L_i0o:
    s_xor_b32 s34, s56, 2
    s_add_u32 s34, s34, s53
    s_cmp_ge_u32 s34, 10
    s_cselect_b32 s33, 10, 0
    s_sub_u32 s34, s34, s33
    s_mul_i32 s34, s34, 81920
    s_add_u32 s34, s34, s35
    s_add_u32 m0, s28, 122880
    s_nop 0
    buffer_load_dwordx4 v5, s[16:19], s34 offen offset:0 lds
    s_add_u32 m0, s28, 123840
    s_nop 0
    buffer_load_dwordx4 v5, s[16:19], s34 offen offset:64 lds
    s_add_u32 m0, s28, 124800
    s_nop 0
    buffer_load_dwordx4 v5, s[16:19], s34 offen offset:128 lds
    s_add_u32 m0, s28, 125760
    s_nop 0
    buffer_load_dwordx4 v5, s[16:19], s34 offen offset:192 lds
    s_add_u32 m0, s28, 126720
    s_nop 0
    buffer_load_dwordx4 v5, s[16:19], s34 offen offset:256 lds
    s_xor_b32 s34, s56, 3
    s_add_u32 s34, s34, s53
    s_cmp_ge_u32 s34, 10
    s_cselect_b32 s33, 10, 0
    s_sub_u32 s34, s34, s33
    s_mul_i32 s34, s34, 81920
    s_add_u32 s34, s34, s35
    s_add_u32 m0, s28, 143360
    s_nop 0
    buffer_load_dwordx4 v5, s[16:19], s34 offen offset:0 lds
    s_add_u32 m0, s28, 144320
    s_nop 0
    buffer_load_dwordx4 v5, s[16:19], s34 offen offset:64 lds
    s_add_u32 m0, s28, 145280
    s_nop 0
    buffer_load_dwordx4 v5, s[16:19], s34 offen offset:128 lds
    s_add_u32 m0, s28, 146240
    s_nop 0
    buffer_load_dwordx4 v5, s[16:19], s34 offen offset:192 lds
    s_add_u32 m0, s28, 147200
    s_nop 0
    buffer_load_dwordx4 v5, s[16:19], s34 offen offset:256 lds
L_i0e:
    ds_read_b64_tr_b16 v[156:157], v192 offset:0
    ds_read_b64_tr_b16 v[158:159], v192 offset:256
    ds_read_b64_tr_b16 v[196:197], v244 offset:0
    ds_read_b64_tr_b16 v[198:199], v244 offset:256
    ds_read_b64_tr_b16 v[160:161], v193 offset:0
    ds_read_b64_tr_b16 v[162:163], v193 offset:256
    ds_read_b64_tr_b16 v[200:201], v245 offset:0
    ds_read_b64_tr_b16 v[202:203], v245 offset:256
    s_waitcnt lgkmcnt(6)
    ds_read_b64_tr_b16 v[164:165], v194 offset:0
    ds_read_b64_tr_b16 v[166:167], v194 offset:256
    ds_read_b64_tr_b16 v[204:205], v246 offset:0
    ds_read_b64_tr_b16 v[206:207], v246 offset:256
    ds_read_b64_tr_b16 v[168:169], v195 offset:0
    ds_read_b64_tr_b16 v[170:171], v195 offset:256
    ds_read_b64_tr_b16 v[208:209], v247 offset:0
    ds_read_b64_tr_b16 v[210:211], v247 offset:256
    s_waitcnt lgkmcnt(0)
    s_waitcnt vmcnt(10)
    s_cbranch_vccnz L_qw1
    s_waitcnt vmcnt(0)
L_qw1:
    s_barrier
    s_cmp_lg_u32 s20, 4
    s_cbranch_scc1 L_nf
    s_and_b32 s33, s50, 63
    v_readlane_b32 s30, v252, s33
    v_readlane_b32 s31, v253, s33
    s_cmp_lt_u32 s50, 64
    s_nop 2
    s_cselect_b32 s30, s30, s31
    s_add_u32 s30, s30, 1
    v_mov_b32 v190, s30
    s_lshl_b32 s33, s50, 4
    s_add_u32 s33, s33, s51
    s_mov_b64 exec, 1
    buffer_store_dword v190, v155, s[8:11], s33 offen sc1
    s_mov_b64 exec, -1
L_nf:
    v_mfma_f32_32x32x16_bf16 v[16:31], v[156:159], v[48:51], v[16:31]
    ds_read_b64_tr_b16 v[228:229], v192 offset:20480
    ds_read_b64_tr_b16 v[230:231], v192 offset:20736
    ds_read_b64_tr_b16 v[212:213], v244 offset:20480
    s_xor_b32 s34, s56, 4
    s_add_u32 s34, s34, s53
    s_cmp_ge_u32 s34, 10
    s_cselect_b32 s33, 10, 0
    s_sub_u32 s34, s34, s33
    s_mul_i32 s34, s34, 81920
    s_add_u32 s34, s34, s35
    s_cbranch_vccnz L_qd1_0
    s_add_u32 m0, s28, 81920
    s_nop 0
    buffer_load_dwordx4 v5, s[16:19], s34 offen offset:0 lds
L_qd1_0:
    v_mfma_f32_16x16x32_bf16 v[32:35], v[196:199], v[48:51], v[32:35]
    ds_read_b64_tr_b16 v[214:215], v244 offset:20736
    ds_read_b64_tr_b16 v[232:233], v193 offset:20480
    ds_read_b64_tr_b16 v[234:235], v193 offset:20736
    s_cbranch_vccnz L_qd1_1
    s_add_u32 m0, s28, 82880
    s_nop 0
    buffer_load_dwordx4 v5, s[16:19], s34 offen offset:64 lds
L_qd1_1:
    v_mfma_f32_32x32x16_bf16 v[16:31], v[160:163], v[52:55], v[16:31]
    ds_read_b64_tr_b16 v[216:217], v245 offset:20480
    ds_read_b64_tr_b16 v[218:219], v245 offset:20736
    ds_read_b64_tr_b16 v[236:237], v194 offset:20480
    s_cbranch_vccnz L_qd1_2
    s_add_u32 m0, s28, 83840
    s_nop 0
    buffer_load_dwordx4 v5, s[16:19], s34 offen offset:128 lds
L_qd1_2:
    v_mfma_f32_16x16x32_bf16 v[32:35], v[200:203], v[52:55], v[32:35]
    ds_read_b64_tr_b16 v[238:239], v194 offset:20736
    ds_read_b64_tr_b16 v[220:221], v246 offset:20480
    ds_read_b64_tr_b16 v[222:223], v246 offset:20736
    s_cbranch_vccnz L_qd1_3
    s_add_u32 m0, s28, 84800
    s_nop 0
    buffer_load_dwordx4 v5, s[16:19], s34 offen offset:192 lds
L_qd1_3:
    v_mfma_f32_32x32x16_bf16 v[16:31], v[164:167], v[56:59], v[16:31]
    ds_read_b64_tr_b16 v[240:241], v195 offset:20480
    ds_read_b64_tr_b16 v[242:243], v195 offset:20736
    ds_read_b64_tr_b16 v[224:225], v247 offset:20480
    s_cbranch_vccnz L_qd1_4
    s_add_u32 m0, s28, 85760
    s_nop 0
    buffer_load_dwordx4 v5, s[16:19], s34 offen offset:256 lds
L_qd1_4:
    v_mfma_f32_16x16x32_bf16 v[32:35], v[204:207], v[56:59], v[32:35]
    s_waitcnt lgkmcnt(8)
    ds_read_b64_tr_b16 v[226:227], v247 offset:20736
    v_mfma_f32_32x32x16_bf16 v[16:31], v[168:171], v[60:63], v[16:31]
    v_mfma_f32_16x16x32_bf16 v[32:35], v[208:211], v[60:63], v[32:35]
    s_waitcnt lgkmcnt(0)
    s_cbranch_vccz L_qw2
    s_waitcnt vmcnt(5)
L_qw2:
    s_barrier
    v_mfma_f32_32x32x16_bf16 v[16:31], v[228:231], v[64:67], v[16:31]
    ds_read_b64_tr_b16 v[156:157], v192 offset:40960
    ds_read_b64_tr_b16 v[158:159], v192 offset:41216
    ds_read_b64_tr_b16 v[196:197], v244 offset:40960
    s_xor_b32 s34, s56, 5
    s_add_u32 s34, s34, s53
    s_cmp_ge_u32 s34, 10
    s_cselect_b32 s33, 10, 0
    s_sub_u32 s34, s34, s33
    s_mul_i32 s34, s34, 81920
    s_add_u32 s34, s34, s35
    s_cbranch_vccz L_qd2_0
    s_add_u32 m0, s28, 102400
    s_nop 0
    buffer_load_dwordx4 v5, s[16:19], s34 offen offset:0 lds
L_qd2_0:
    v_mfma_f32_16x16x32_bf16 v[32:35], v[212:215], v[64:67], v[32:35]
    ds_read_b64_tr_b16 v[198:199], v244 offset:41216
    ds_read_b64_tr_b16 v[160:161], v193 offset:40960
    ds_read_b64_tr_b16 v[162:163], v193 offset:41216
    s_cbranch_vccz L_qd2_1
    s_add_u32 m0, s28, 103360
    s_nop 0
    buffer_load_dwordx4 v5, s[16:19], s34 offen offset:64 lds
L_qd2_1:
    v_mfma_f32_32x32x16_bf16 v[16:31], v[232:235], v[68:71], v[16:31]
    ds_read_b64_tr_b16 v[200:201], v245 offset:40960
    ds_read_b64_tr_b16 v[202:203], v245 offset:41216
    ds_read_b64_tr_b16 v[164:165], v194 offset:40960
    s_cbranch_vccz L_qd2_2
    s_add_u32 m0, s28, 104320
    s_nop 0
    buffer_load_dwordx4 v5, s[16:19], s34 offen offset:128 lds
L_qd2_2:
    v_mfma_f32_16x16x32_bf16 v[32:35], v[216:219], v[68:71], v[32:35]
    ds_read_b64_tr_b16 v[166:167], v194 offset:41216
    ds_read_b64_tr_b16 v[204:205], v246 offset:40960
    ds_read_b64_tr_b16 v[206:207], v246 offset:41216
    s_cbranch_vccz L_qd2_3
    s_add_u32 m0, s28, 105280
    s_nop 0
    buffer_load_dwordx4 v5, s[16:19], s34 offen offset:192 lds
L_qd2_3:
    v_mfma_f32_32x32x16_bf16 v[16:31], v[236:239], v[72:75], v[16:31]
    ds_read_b64_tr_b16 v[168:169], v195 offset:40960
    ds_read_b64_tr_b16 v[170:171], v195 offset:41216
    ds_read_b64_tr_b16 v[208:209], v247 offset:40960
    s_cbranch_vccz L_qd2_4
    s_add_u32 m0, s28, 106240
    s_nop 0
    buffer_load_dwordx4 v5, s[16:19], s34 offen offset:256 lds
L_qd2_4:
    v_mfma_f32_16x16x32_bf16 v[32:35], v[220:223], v[72:75], v[32:35]
    s_waitcnt lgkmcnt(8)
    ds_read_b64_tr_b16 v[210:211], v247 offset:41216
    v_mfma_f32_32x32x16_bf16 v[16:31], v[240:243], v[76:79], v[16:31]
    v_mfma_f32_16x16x32_bf16 v[32:35], v[224:227], v[76:79], v[32:35]
    s_waitcnt lgkmcnt(0)
    s_cbranch_vccz L_qw3
    s_waitcnt vmcnt(5)
L_qw3:
    s_barrier
    v_mfma_f32_32x32x16_bf16 v[16:31], v[156:159], v[80:83], v[16:31]
    ds_read_b64_tr_b16 v[228:229], v192 offset:61440
    ds_read_b64_tr_b16 v[230:231], v192 offset:61696
    ds_read_b64_tr_b16 v[212:213], v244 offset:61440
    s_xor_b32 s34, s56, 6
    s_add_u32 s34, s34, s53
    s_cmp_ge_u32 s34, 10
    s_cselect_b32 s33, 10, 0
    s_sub_u32 s34, s34, s33
    s_mul_i32 s34, s34, 81920
    s_add_u32 s34, s34, s35
    s_cbranch_vccnz L_qd3_0
    s_add_u32 m0, s28, 122880
    s_nop 0
    buffer_load_dwordx4 v5, s[16:19], s34 offen offset:0 lds
L_qd3_0:
    v_mfma_f32_16x16x32_bf16 v[32:35], v[196:199], v[80:83], v[32:35]
    ds_read_b64_tr_b16 v[214:215], v244 offset:61696
    ds_read_b64_tr_b16 v[232:233], v193 offset:61440
    ds_read_b64_tr_b16 v[234:235], v193 offset:61696
    s_cbranch_vccnz L_qd3_1
    s_add_u32 m0, s28, 123840
    s_nop 0
    buffer_load_dwordx4 v5, s[16:19], s34 offen offset:64 lds
L_qd3_1:
    v_mfma_f32_32x32x16_bf16 v[16:31], v[160:163], v[84:87], v[16:31]
    ds_read_b64_tr_b16 v[216:217], v245 offset:61440
    ds_read_b64_tr_b16 v[218:219], v245 offset:61696
    ds_read_b64_tr_b16 v[236:237], v194 offset:61440
    s_cbranch_vccnz L_qd3_2
    s_add_u32 m0, s28, 124800
    s_nop 0
    buffer_load_dwordx4 v5, s[16:19], s34 offen offset:128 lds
L_qd3_2:
    v_mfma_f32_16x16x32_bf16 v[32:35], v[200:203], v[84:87], v[32:35]
    ds_read_b64_tr_b16 v[238:239], v194 offset:61696
    ds_read_b64_tr_b16 v[220:221], v246 offset:61440
    ds_read_b64_tr_b16 v[222:223], v246 offset:61696
    s_cbranch_vccnz L_qd3_3
    s_add_u32 m0, s28, 125760
    s_nop 0
    buffer_load_dwordx4 v5, s[16:19], s34 offen offset:192 lds
L_qd3_3:
    v_mfma_f32_32x32x16_bf16 v[16:31], v[164:167], v[88:91], v[16:31]
    ds_read_b64_tr_b16 v[240:241], v195 offset:61440
    ds_read_b64_tr_b16 v[242:243], v195 offset:61696
    ds_read_b64_tr_b16 v[224:225], v247 offset:61440
    s_cbranch_vccnz L_qd3_4
    s_add_u32 m0, s28, 126720
    s_nop 0
    buffer_load_dwordx4 v5, s[16:19], s34 offen offset:256 lds
L_qd3_4:
    v_mfma_f32_16x16x32_bf16 v[32:35], v[204:207], v[88:91], v[32:35]
    s_waitcnt lgkmcnt(8)
    ds_read_b64_tr_b16 v[226:227], v247 offset:61696
    v_mfma_f32_32x32x16_bf16 v[16:31], v[168:171], v[92:95], v[16:31]
    s_waitcnt lgkmcnt(8)
    ds_read_b128 v[48:51], v144 offset:32768
    ds_read_b128 v[52:55], v145 offset:32768
    ds_read_b128 v[56:59], v146 offset:32768
    ds_read_b128 v[60:63], v147 offset:32768
    v_mfma_f32_16x16x32_bf16 v[32:35], v[208:211], v[92:95], v[32:35]
    s_waitcnt lgkmcnt(0)
    s_cbranch_vccnz L_qw4
    s_waitcnt vmcnt(5)
L_qw4:
    s_barrier
    v_mfma_f32_32x32x16_bf16 v[16:31], v[228:231], v[96:99], v[16:31]
    ds_read_b64_tr_b16 v[156:157], v192 offset:0
    ds_read_b64_tr_b16 v[158:159], v192 offset:256
    ds_read_b64_tr_b16 v[196:197], v244 offset:0
    s_xor_b32 s34, s56, 7
    s_add_u32 s34, s34, s53
    s_cmp_ge_u32 s34, 10
    s_cselect_b32 s33, 10, 0
    s_sub_u32 s34, s34, s33
    s_mul_i32 s34, s34, 81920
    s_add_u32 s34, s34, s35
    s_cbranch_vccz L_qd4_0
    s_add_u32 m0, s28, 143360
    s_nop 0
    buffer_load_dwordx4 v5, s[16:19], s34 offen offset:0 lds
L_qd4_0:
    v_mfma_f32_16x16x32_bf16 v[32:35], v[212:215], v[96:99], v[32:35]
    ds_read_b64_tr_b16 v[198:199], v244 offset:256
    ds_read_b64_tr_b16 v[160:161], v193 offset:0
    ds_read_b64_tr_b16 v[162:163], v193 offset:256
    s_cbranch_vccz L_qd4_1
    s_add_u32 m0, s28, 144320
    s_nop 0
    buffer_load_dwordx4 v5, s[16:19], s34 offen offset:64 lds
L_qd4_1:
    v_mfma_f32_32x32x16_bf16 v[16:31], v[232:235], v[100:103], v[16:31]
    ds_read_b64_tr_b16 v[200:201], v245 offset:0
    ds_read_b64_tr_b16 v[202:203], v245 offset:256
    ds_read_b64_tr_b16 v[164:165], v194 offset:0
    s_cbranch_vccz L_qd4_2
    s_add_u32 m0, s28, 145280
    s_nop 0
    buffer_load_dwordx4 v5, s[16:19], s34 offen offset:128 lds
L_qd4_2:
    v_mfma_f32_16x16x32_bf16 v[32:35], v[216:219], v[100:103], v[32:35]
    ds_read_b64_tr_b16 v[166:167], v194 offset:256
    ds_read_b64_tr_b16 v[204:205], v246 offset:0
    ds_read_b64_tr_b16 v[206:207], v246 offset:256
    s_cbranch_vccz L_qd4_3
    s_add_u32 m0, s28, 146240
    s_nop 0
    buffer_load_dwordx4 v5, s[16:19], s34 offen offset:192 lds
L_qd4_3:
    v_mfma_f32_32x32x16_bf16 v[16:31], v[236:239], v[104:107], v[16:31]
    ds_read_b64_tr_b16 v[168:169], v195 offset:0
    ds_read_b64_tr_b16 v[170:171], v195 offset:256
    ds_read_b64_tr_b16 v[208:209], v247 offset:0
    s_cbranch_vccz L_qd4_4
    s_add_u32 m0, s28, 147200
    s_nop 0
    buffer_load_dwordx4 v5, s[16:19], s34 offen offset:256 lds
L_qd4_4:
    v_mfma_f32_16x16x32_bf16 v[32:35], v[220:223], v[104:107], v[32:35]
    s_waitcnt lgkmcnt(8)
    ds_read_b64_tr_b16 v[210:211], v247 offset:256
    v_mfma_f32_32x32x16_bf16 v[16:31], v[240:243], v[108:111], v[16:31]
    s_waitcnt lgkmcnt(8)
    ds_read_b128 v[64:67], v148 offset:32768
    ds_read_b128 v[68:71], v149 offset:32768
    ds_read_b128 v[72:75], v150 offset:32768
    ds_read_b128 v[76:79], v151 offset:32768
    v_mfma_f32_16x16x32_bf16 v[32:35], v[224:227], v[108:111], v[32:35]
    s_lshr_b32 s33, s56, 1
    s_lshl_b32 s33, s33, 14
    s_add_u32 s33, s33, 49152
    v_add_u32 v144, s33, v144
    v_add_u32 v145, s33, v145
    v_add_u32 v146, s33, v146
    v_add_u32 v147, s33, v147
    v_add_u32 v148, s33, v148
    v_add_u32 v149, s33, v149
    v_add_u32 v150, s33, v150
    v_add_u32 v151, s33, v151
    s_waitcnt lgkmcnt(0)
    s_cbranch_vccz L_qw5
    s_waitcnt vmcnt(5)
L_qw5:
    s_barrier
    s_cmp_lg_u32 s20, 4
    s_cbranch_scc1 L_np
    buffer_load_dword v254, v1, s[8:11], s51 offen sc1
    buffer_load_dword v255, v1, s[8:11], s51 offen offset:1024 sc1
L_np:
    v_mfma_f32_32x32x16_bf16 v[16:31], v[156:159], v[112:115], v[16:31]
    ds_read_b64_tr_b16 v[228:229], v192 offset:20480
    ds_read_b64_tr_b16 v[230:231], v192 offset:20736
    ds_read_b64_tr_b16 v[212:213], v244 offset:20480
    s_xor_b32 s34, s57, 8
    s_add_u32 s34, s34, s53
    s_cmp_ge_u32 s34, 10
    s_cselect_b32 s33, 10, 0
    s_sub_u32 s34, s34, s33
    s_mul_i32 s34, s34, 81920
    s_add_u32 s34, s34, s35
    s_cbranch_vccnz L_qd5_0
    s_add_u32 m0, s28, 81920
    s_nop 0
    buffer_load_dwordx4 v5, s[16:19], s34 offen offset:0 lds
L_qd5_0:
    v_mov_b32 v80, 0
    v_mov_b32 v81, 0
    v_mfma_f32_16x16x32_bf16 v[32:35], v[196:199], v[112:115], v[32:35]
    ds_read_b64_tr_b16 v[214:215], v244 offset:20736
    ds_read_b64_tr_b16 v[232:233], v193 offset:20480
    ds_read_b64_tr_b16 v[234:235], v193 offset:20736
    s_cbranch_vccnz L_qd5_1
    s_add_u32 m0, s28, 82880
    s_nop 0
    buffer_load_dwordx4 v5, s[16:19], s34 offen offset:64 lds
L_qd5_1:
    v_mov_b32 v82, 0
    v_mov_b32 v83, 0
    v_mfma_f32_32x32x16_bf16 v[16:31], v[160:163], v[116:119], v[16:31]
    ds_read_b64_tr_b16 v[216:217], v245 offset:20480
    ds_read_b64_tr_b16 v[218:219], v245 offset:20736
    ds_read_b64_tr_b16 v[236:237], v194 offset:20480
    s_cbranch_vccnz L_qd5_2
    s_add_u32 m0, s28, 83840
    s_nop 0
    buffer_load_dwordx4 v5, s[16:19], s34 offen offset:128 lds
L_qd5_2:
    v_mov_b32 v84, 0
    v_mov_b32 v85, 0
    v_mfma_f32_16x16x32_bf16 v[32:35], v[200:203], v[116:119], v[32:35]
    ds_read_b64_tr_b16 v[238:239], v194 offset:20736
    ds_read_b64_tr_b16 v[220:221], v246 offset:20480
    ds_read_b64_tr_b16 v[222:223], v246 offset:20736
    s_cbranch_vccnz L_qd5_3
    s_add_u32 m0, s28, 84800
    s_nop 0
    buffer_load_dwordx4 v5, s[16:19], s34 offen offset:192 lds
L_qd5_3:
    v_mov_b32 v86, 0
    v_mov_b32 v87, 0
    v_mfma_f32_32x32x16_bf16 v[16:31], v[164:167], v[120:123], v[16:31]
    ds_read_b64_tr_b16 v[240:241], v195 offset:20480
    ds_read_b64_tr_b16 v[242:243], v195 offset:20736
    ds_read_b64_tr_b16 v[224:225], v247 offset:20480
    s_cbranch_vccnz L_qd5_4
    s_add_u32 m0, s28, 85760
    s_nop 0
    buffer_load_dwordx4 v5, s[16:19], s34 offen offset:256 lds
L_qd5_4:
    v_mov_b32 v88, 0
    v_mov_b32 v89, 0
    v_mfma_f32_16x16x32_bf16 v[32:35], v[204:207], v[120:123], v[32:35]
    s_waitcnt lgkmcnt(8)
    ds_read_b64_tr_b16 v[226:227], v247 offset:20736
    v_mov_b32 v90, 0
    v_mov_b32 v91, 0
    v_mfma_f32_32x32x16_bf16 v[16:31], v[168:171], v[124:127], v[16:31]
    v_mov_b32 v92, 0
    v_mov_b32 v93, 0
    v_mfma_f32_16x16x32_bf16 v[32:35], v[208:211], v[124:127], v[32:35]
    v_mov_b32 v94, 0
    v_mov_b32 v95, 0
    s_waitcnt lgkmcnt(0)
    s_cbranch_vccnz L_qw6
    s_waitcnt vmcnt(5)
L_qw6:
    s_barrier
    v_mfma_f32_32x32x16_bf16 v[16:31], v[228:231], v[128:131], v[16:31]
    ds_read_b64_tr_b16 v[156:157], v192 offset:40960
    ds_read_b64_tr_b16 v[158:159], v192 offset:41216
    ds_read_b64_tr_b16 v[196:197], v244 offset:40960
    s_xor_b32 s34, s57, 9
    s_add_u32 s34, s34, s53
    s_cmp_ge_u32 s34, 10
    s_cselect_b32 s33, 10, 0
    s_sub_u32 s34, s34, s33
    s_mul_i32 s34, s34, 81920
    s_add_u32 s34, s34, s35
    s_cbranch_vccz L_qd6_0
    s_add_u32 m0, s28, 102400
    s_nop 0
    buffer_load_dwordx4 v5, s[16:19], s34 offen offset:0 lds
L_qd6_0:
    v_mov_b32 v96, 0
    v_mov_b32 v97, 0
    v_mfma_f32_16x16x32_bf16 v[32:35], v[212:215], v[128:131], v[32:35]
    ds_read_b64_tr_b16 v[198:199], v244 offset:41216
    ds_read_b64_tr_b16 v[160:161], v193 offset:40960
    ds_read_b64_tr_b16 v[162:163], v193 offset:41216
    s_cbranch_vccz L_qd6_1
    s_add_u32 m0, s28, 103360
    s_nop 0
    buffer_load_dwordx4 v5, s[16:19], s34 offen offset:64 lds
L_qd6_1:
    v_mov_b32 v98, 0
    v_mov_b32 v99, 0
    v_mfma_f32_32x32x16_bf16 v[16:31], v[232:235], v[132:135], v[16:31]
    ds_read_b64_tr_b16 v[200:201], v245 offset:40960
    ds_read_b64_tr_b16 v[202:203], v245 offset:41216
    ds_read_b64_tr_b16 v[164:165], v194 offset:40960
    s_cbranch_vccz L_qd6_2
    s_add_u32 m0, s28, 104320
    s_nop 0
    buffer_load_dwordx4 v5, s[16:19], s34 offen offset:128 lds
L_qd6_2:
    v_mov_b32 v100, 0
    v_mov_b32 v101, 0
    v_mfma_f32_16x16x32_bf16 v[32:35], v[216:219], v[132:135], v[32:35]
    ds_read_b64_tr_b16 v[166:167], v194 offset:41216
    ds_read_b64_tr_b16 v[204:205], v246 offset:40960
    ds_read_b64_tr_b16 v[206:207], v246 offset:41216
    s_cbranch_vccz L_qd6_3
    s_add_u32 m0, s28, 105280
    s_nop 0
    buffer_load_dwordx4 v5, s[16:19], s34 offen offset:192 lds
L_qd6_3:
    v_mov_b32 v102, 0
    v_mov_b32 v103, 0
    v_mfma_f32_32x32x16_bf16 v[16:31], v[236:239], v[136:139], v[16:31]
    ds_read_b64_tr_b16 v[168:169], v195 offset:40960
    ds_read_b64_tr_b16 v[170:171], v195 offset:41216
    ds_read_b64_tr_b16 v[208:209], v247 offset:40960
    s_cbranch_vccz L_qd6_4
    s_add_u32 m0, s28, 106240
    s_nop 0
    buffer_load_dwordx4 v5, s[16:19], s34 offen offset:256 lds
L_qd6_4:
    v_mov_b32 v104, 0
    v_mov_b32 v105, 0
    v_mfma_f32_16x16x32_bf16 v[32:35], v[220:223], v[136:139], v[32:35]
    s_waitcnt lgkmcnt(8)
    ds_read_b64_tr_b16 v[210:211], v247 offset:41216
    v_mov_b32 v106, 0
    v_mov_b32 v107, 0
    v_mfma_f32_32x32x16_bf16 v[16:31], v[240:243], v[140:143], v[16:31]
    v_mov_b32 v108, 0
    v_mov_b32 v109, 0
    v_mfma_f32_16x16x32_bf16 v[32:35], v[224:227], v[140:143], v[32:35]
    v_mov_b32 v110, 0
    v_mov_b32 v111, 0
    s_waitcnt lgkmcnt(0)
    s_cbranch_vccz L_qw7
    s_waitcnt vmcnt(5)
L_qw7:
    s_cmp_lg_u32 s20, 4
    s_cbranch_scc1 L_pdone
    s_mov_b32 s30, 0
    s_lshl_b32 s31, s23, 7
    s_waitcnt vmcnt(5)
L_poll:
    v_cmp_eq_u32 s[4:5], v254, v252
    v_cmp_eq_u32 s[48:49], v255, v253
    s_add_u32 s30, s30, 1
    s_nop 0
    s_or_b64 s[4:5], s[4:5], s[48:49]
    s_cbranch_scc0 L_pdone
    s_cmp_ge_u32 s30, 60000
    s_cbranch_scc1 L_pdone
    s_cmp_lg_u32 s30, 1
    s_cbranch_scc1 L_pna
    v_mov_b32 v190, 1
    s_mov_b32 s52, 1
    s_mov_b64 exec, 1
    buffer_atomic_add v190, v155, s[72:75], s31 offen
    s_mov_b64 exec, -1
L_pna:
    s_and_b32 s33, s30, 7
    s_cbranch_scc1 L_pnc
    buffer_load_dword v190, v155, s[72:75], s31 offen sc1
    s_waitcnt vmcnt(0)
    v_readfirstlane_b32 s33, v190
    s_nop 3
    s_cmp_ge_u32 s33, 128
    s_cbranch_scc1 L_pdone
L_pnc:
    s_sleep 2
    buffer_load_dword v254, v1, s[8:11], s51 offen sc1
    buffer_load_dword v255, v1, s[8:11], s51 offen offset:1024 sc1
    s_waitcnt vmcnt(0)
    s_branch L_poll
L_pdone:
    s_barrier
    s_lshl_b32 s33, s23, 10
    s_add_u32 s33, s33, 327680
    buffer_load_dwordx4 v[12:15], v1, s[8:11], s33 offen sc1
    s_lshl_b32 s7, s20, 10
    s_add_u32 s6, s26, s3
    s_add_u32 s6, s6, s7
    v_mfma_f32_32x32x16_bf16 v[16:31], v[156:159], v[48:51], v[16:31]
    ds_read_b64_tr_b16 v[228:229], v192 offset:61440
    ds_read_b64_tr_b16 v[230:231], v192 offset:61696
    ds_read_b64_tr_b16 v[212:213], v244 offset:61440
    s_mov_b32 m0, s7
    s_add_u32 s7, s7, 8192
    buffer_load_dwordx4 v1, s[8:11], s6 offen sc1 lds
    s_add_u32 s6, s6, 8192
    v_mfma_f32_16x16x32_bf16 v[32:35], v[196:199], v[48:51], v[32:35]
    ds_read_b64_tr_b16 v[214:215], v244 offset:61696
    ds_read_b64_tr_b16 v[232:233], v193 offset:61440
    ds_read_b64_tr_b16 v[234:235], v193 offset:61696
    s_mov_b32 m0, s7
    s_add_u32 s7, s7, 8192
    buffer_load_dwordx4 v1, s[8:11], s6 offen sc1 lds
    s_add_u32 s6, s6, 8192
    v_mfma_f32_32x32x16_bf16 v[16:31], v[160:163], v[52:55], v[16:31]
    ds_read_b64_tr_b16 v[216:217], v245 offset:61440
    ds_read_b64_tr_b16 v[218:219], v245 offset:61696
    ds_read_b64_tr_b16 v[236:237], v194 offset:61440
    s_mov_b32 m0, s7
    s_add_u32 s7, s7, 8192
    buffer_load_dwordx4 v1, s[8:11], s6 offen sc1 lds
    s_add_u32 s6, s6, 8192
    v_mfma_f32_16x16x32_bf16 v[32:35], v[200:203], v[52:55], v[32:35]
    ds_read_b64_tr_b16 v[238:239], v194 offset:61696
    ds_read_b64_tr_b16 v[220:221], v246 offset:61440
    ds_read_b64_tr_b16 v[222:223], v246 offset:61696
    v_mfma_f32_32x32x16_bf16 v[16:31], v[164:167], v[56:59], v[16:31]
    ds_read_b64_tr_b16 v[240:241], v195 offset:61440
    ds_read_b64_tr_b16 v[242:243], v195 offset:61696
    ds_read_b64_tr_b16 v[224:225], v247 offset:61440
    v_mfma_f32_16x16x32_bf16 v[32:35], v[204:207], v[56:59], v[32:35]
    s_waitcnt lgkmcnt(8)
    ds_read_b64_tr_b16 v[226:227], v247 offset:61696
    v_mfma_f32_32x32x16_bf16 v[16:31], v[168:171], v[60:63], v[16:31]
    s_waitcnt lgkmcnt(8)
    ds_read_b128 v[112:115], v144 offset:0
    ds_read_b128 v[116:119], v145 offset:0
    ds_read_b128 v[120:123], v146 offset:0
    ds_read_b128 v[124:127], v147 offset:0
    v_mfma_f32_16x16x32_bf16 v[32:35], v[208:211], v[60:63], v[32:35]
    s_waitcnt lgkmcnt(0)
    s_cbranch_vccnz L_qw8
    s_waitcnt vmcnt(4)
L_qw8:
    s_barrier
    v_mfma_f32_32x32x16_bf16 v[16:31], v[228:231], v[64:67], v[16:31]
    ds_read_b64_tr_b16 v[156:157], v192 offset:0
    ds_read_b64_tr_b16 v[158:159], v192 offset:256
    ds_read_b64_tr_b16 v[196:197], v244 offset:0
    s_mov_b32 m0, s7
    s_add_u32 s7, s7, 8192
    buffer_load_dwordx4 v1, s[8:11], s6 offen sc1 lds
    s_add_u32 s6, s6, 8192
    v_mfma_f32_16x16x32_bf16 v[32:35], v[212:215], v[64:67], v[32:35]
    ds_read_b64_tr_b16 v[198:199], v244 offset:256
    ds_read_b64_tr_b16 v[160:161], v193 offset:0
    ds_read_b64_tr_b16 v[162:163], v193 offset:256
    s_mov_b32 m0, s7
    s_add_u32 s7, s7, 8192
    buffer_load_dwordx4 v1, s[8:11], s6 offen sc1 lds
    s_add_u32 s6, s6, 8192
    v_mfma_f32_32x32x16_bf16 v[16:31], v[232:235], v[68:71], v[16:31]
    ds_read_b64_tr_b16 v[200:201], v245 offset:0
    ds_read_b64_tr_b16 v[202:203], v245 offset:256
    ds_read_b64_tr_b16 v[164:165], v194 offset:0
    v_mfma_f32_16x16x32_bf16 v[32:35], v[216:219], v[68:71], v[32:35]
    ds_read_b64_tr_b16 v[166:167], v194 offset:256
    ds_read_b64_tr_b16 v[204:205], v246 offset:0
    ds_read_b64_tr_b16 v[206:207], v246 offset:256
    v_mfma_f32_32x32x16_bf16 v[16:31], v[236:239], v[72:75], v[16:31]
    ds_read_b64_tr_b16 v[168:169], v195 offset:0
    ds_read_b64_tr_b16 v[170:171], v195 offset:256
    ds_read_b64_tr_b16 v[208:209], v247 offset:0
    v_mfma_f32_16x16x32_bf16 v[32:35], v[220:223], v[72:75], v[32:35]
    s_waitcnt lgkmcnt(8)
    ds_read_b64_tr_b16 v[210:211], v247 offset:256
    v_mfma_f32_32x32x16_bf16 v[16:31], v[240:243], v[76:79], v[16:31]
    s_waitcnt lgkmcnt(8)
    ds_read_b128 v[128:131], v148 offset:0
    ds_read_b128 v[132:135], v149 offset:0
    ds_read_b128 v[136:139], v150 offset:0
    ds_read_b128 v[140:143], v151 offset:0
    v_mfma_f32_16x16x32_bf16 v[32:35], v[224:227], v[76:79], v[32:35]
    s_waitcnt lgkmcnt(0)
    s_cbranch_vccz L_qw9
    s_waitcnt vmcnt(6)
L_qw9:
    s_barrier
    s_mov_b32 s30, 0x000fffff
    s_mov_b32 s31, 0x000fffff
    s_cbranch_vccz L_bwave
    s_setprio 2
    v_mfma_f32_32x32x16_bf16 v[16:31], v[156:159], v[112:115], v[16:31]
    ds_read_b64_tr_b16 v[228:229], v192 offset:20480
    ds_read_b64_tr_b16 v[230:231], v192 offset:20736
    ds_read_b64_tr_b16 v[212:213], v244 offset:20480
    ds_read_b64_tr_b16 v[214:215], v244 offset:20736
    v_mfma_f32_16x16x32_bf16 v[32:35], v[196:199], v[112:115], v[32:35]
    ds_read_b64_tr_b16 v[232:233], v193 offset:20480
    ds_read_b64_tr_b16 v[234:235], v193 offset:20736
    ds_read_b64_tr_b16 v[216:217], v245 offset:20480
    ds_read_b64_tr_b16 v[218:219], v245 offset:20736
    v_mfma_f32_32x32x16_bf16 v[16:31], v[160:163], v[116:119], v[16:31]
    ds_read_b64_tr_b16 v[236:237], v194 offset:20480
    ds_read_b64_tr_b16 v[238:239], v194 offset:20736
    ds_read_b64_tr_b16 v[220:221], v246 offset:20480
    ds_read_b64_tr_b16 v[222:223], v246 offset:20736
    v_mfma_f32_16x16x32_bf16 v[32:35], v[200:203], v[116:119], v[32:35]
    s_waitcnt lgkmcnt(6)
    ds_read_b64_tr_b16 v[240:241], v195 offset:20480
    ds_read_b64_tr_b16 v[242:243], v195 offset:20736
    ds_read_b64_tr_b16 v[224:225], v247 offset:20480
    ds_read_b64_tr_b16 v[226:227], v247 offset:20736
    v_mfma_f32_32x32x16_bf16 v[16:31], v[164:167], v[120:123], v[16:31]
    v_mfma_f32_16x16x32_bf16 v[32:35], v[204:207], v[120:123], v[32:35]
    s_waitcnt vmcnt(5)
    v_max3_f32 v12, v12, v13, v14
    v_max_f32 v12, v12, v15
    s_nop 1
    v_max_f32_dpp v12, v12, v12 row_ror:8 row_mask:0xf bank_mask:0xf
    s_nop 1
    v_max_f32_dpp v12, v12, v12 row_ror:4 row_mask:0xf bank_mask:0xf
    s_nop 1
    v_mfma_f32_32x32x16_bf16 v[16:31], v[168:171], v[124:127], v[16:31]
    v_max_f32_dpp v12, v12, v12 row_ror:2 row_mask:0xf bank_mask:0xf
    s_nop 1
    v_max_f32_dpp v12, v12, v12 row_ror:1 row_mask:0xf bank_mask:0xf
    v_mov_b32 v13, v12
    s_nop 1
    v_permlane16_swap_b32 v12, v13
    v_max_f32 v12, v12, v13
    v_mov_b32 v13, v12
    v_mfma_f32_16x16x32_bf16 v[32:35], v[208:211], v[124:127], v[32:35]
    s_nop 1
    v_permlane32_swap_b32 v12, v13
    v_add_f32 v12, v12, v13
    v_sqrt_f32 v12, v12
    s_nop 0
    v_mul_f32 v12, 0xbf8147ae, v12
    s_waitcnt vmcnt(0) lgkmcnt(0)
    s_barrier
L_tJ:
    v_mfma_f32_32x32x16_bf16 v[16:31], v[228:231], v[128:131], v[16:31]
    ds_read_b128 v[156:159], v188 offset:0
    ds_read_b128 v[160:163], v188 offset:1024
    ds_read_b128 v[164:167], v188 offset:4096
    s_mov_b64 exec, s[30:31]
    ds_read_b128 v[172:175], v189 offset:5120
    ds_read_b128 v[176:179], v189 offset:5760
    s_mov_b64 exec, -1
    v_mfma_f32_32x32x16_bf16 v[16:31], v[232:235], v[132:135], v[16:31]
    v_mov_b32 v72, 0
    v_mov_b32 v73, 0
    v_mov_b32 v74, 0
    v_mov_b32 v75, 0
    v_mfma_f32_32x32x16_bf16 v[16:31], v[236:239], v[136:139], v[16:31]
    v_mov_b32 v76, 0
    v_mov_b32 v77, 0
    v_mov_b32 v78, 0
    v_mov_b32 v79, 0
    v_mfma_f32_32x32x16_bf16 v[16:31], v[240:243], v[140:143], v[16:31]
    v_mfma_f32_16x16x32_bf16 v[32:35], v[212:215], v[128:131], v[32:35]
    v_mfma_f32_16x16x32_bf16 v[32:35], v[216:219], v[132:135], v[32:35]
    v_mfma_f32_16x16x32_bf16 v[32:35], v[220:223], v[136:139], v[32:35]
    v_mfma_f32_16x16x32_bf16 v[32:35], v[224:227], v[140:143], v[32:35]
    s_nop 7
    v_cvt_pk_bf16_f32 v144, v16, v17
    v_cvt_pk_bf16_f32 v145, v18, v19
    v_cvt_pk_bf16_f32 v146, v20, v21
    v_cvt_pk_bf16_f32 v147, v22, v23
    v_cvt_pk_bf16_f32 v148, v24, v25
    v_cvt_pk_bf16_f32 v149, v26, v27
    v_cvt_pk_bf16_f32 v150, v28, v29
    v_cvt_pk_bf16_f32 v151, v30, v31
    v_mul_f32 v68, v16, v16
    v_fmac_f32 v68, v17, v17
    v_fmac_f32 v68, v18, v18
    v_fmac_f32 v68, v19, v19
    v_fmac_f32 v68, v20, v20
    v_fmac_f32 v68, v21, v21
    v_fmac_f32 v68, v22, v22
    v_fmac_f32 v68, v23, v23
    v_mul_f32 v69, v24, v24
    v_fmac_f32 v69, v25, v25
    v_fmac_f32 v69, v26, v26
    v_fmac_f32 v69, v27, v27
    v_fmac_f32 v69, v28, v28
    v_fmac_f32 v69, v29, v29
    v_fmac_f32 v69, v30, v30
    v_fmac_f32 v69, v31, v31
    v_mov_b32 v48, v68
    v_mov_b32 v49, v69
    v_cvt_pk_bf16_f32 v152, v32, v33
    v_cvt_pk_bf16_f32 v153, v34, v35
    v_mul_f32 v56, v32, v32
    v_fmac_f32 v56, v33, v33
    v_fmac_f32 v56, v34, v34
    v_fmac_f32 v56, v35, v35
    s_mov_b32 exec_hi, 0
    v_add_f32 v48, v48, v56
    s_mov_b64 exec, -1
    s_mov_b32 exec_lo, 0
    v_add_f32 v49, v49, v56
    s_mov_b64 exec, -1
    v_mov_b32 v50, v48
    v_mov_b32 v51, v49
    s_nop 0
    v_permlane32_swap_b32 v48, v50
    v_permlane32_swap_b32 v49, v51
    v_add_f32 v48, v48, v50
    v_add_f32 v49, v49, v51
    v_sqrt_f32 v48, v48
    v_sqrt_f32 v49, v49
    v_mov_b32 v51, 0xc2200000
    v_mul_f32 v48, v48, v12
    v_mul_f32 v49, v49, v12
    v_min_f32 v50, v48, v49
    v_cmp_nge_f32 vcc, v50, v51
    s_mov_b32 s35, 37832
    s_mov_b32 s32, 6
    s_cmp_lt_u32 s20, 4
    s_cbranch_scc0 L_bw2
    s_cmp_lg_u64 vcc, 0
    s_cbranch_scc1 L_aslow
L_go:
    v_pk_mov_b32 v[112:113], v[48:49], v[48:49] op_sel:[0,0]
    v_pk_mov_b32 v[114:115], v[48:49], v[48:49] op_sel:[0,0]
    v_pk_mov_b32 v[116:117], v[48:49], v[48:49] op_sel:[0,0]
    v_pk_mov_b32 v[118:119], v[48:49], v[48:49] op_sel:[0,0]
    v_pk_mov_b32 v[120:121], v[48:49], v[48:49] op_sel:[0,0]
    v_pk_mov_b32 v[122:123], v[48:49], v[48:49] op_sel:[0,0]
    v_pk_mov_b32 v[124:125], v[48:49], v[48:49] op_sel:[0,0]
    v_pk_mov_b32 v[126:127], v[48:49], v[48:49] op_sel:[0,0]
    v_pk_mov_b32 v[128:129], v[48:49], v[48:49] op_sel:[1,1]
    v_pk_mov_b32 v[130:131], v[48:49], v[48:49] op_sel:[1,1]
    v_pk_mov_b32 v[132:133], v[48:49], v[48:49] op_sel:[1,1]
    v_pk_mov_b32 v[134:135], v[48:49], v[48:49] op_sel:[1,1]
    v_pk_mov_b32 v[136:137], v[48:49], v[48:49] op_sel:[1,1]
    v_pk_mov_b32 v[138:139], v[48:49], v[48:49] op_sel:[1,1]
    v_pk_mov_b32 v[140:141], v[48:49], v[48:49] op_sel:[1,1]
    v_pk_mov_b32 v[142:143], v[48:49], v[48:49] op_sel:[1,1]
    s_waitcnt lgkmcnt(0)
    s_nop 0
    v_mfma_f32_32x32x16_bf16 v[16:31], v[156:159], v[144:147], v[112:127]
    v_mfma_f32_32x32x16_bf16 v[32:47], v[156:159], v[148:151], v[128:143]
    s_nop 9
    v_mfma_f32_32x32x4_2b_bf16 v[16:47], v[164:165], v[152:153], v[16:47] cbsz:1 abid:0
    s_mov_b32 s34, 0
    s_cmp_lt_u32 s20, 4
    s_nop 15
    s_nop 1
    s_cbranch_scc1 L_loop
    s_setprio 1
.p2align 6
L_loop:
    v_exp_f32 v16, v16
    v_exp_f32 v17, v17
    v_smfmac_f32_32x32x32_bf16 v[96:111], v[184:187], v[72:79], v154
    s_waitcnt lgkmcnt(0)
    v_exp_f32 v18, v18
    v_exp_f32 v19, v19
    v_exp_f32 v20, v20
    v_mfma_f32_32x32x4_2b_bf16 v[48:79], v[164:165], v[152:153], v[112:143] cbsz:1 abid:1
    v_exp_f32 v21, v21
    v_exp_f32 v22, v22
    v_exp_f32 v23, v23
    v_exp_f32 v24, v24
    v_exp_f32 v25, v25
    v_exp_f32 v26, v26
    v_exp_f32 v27, v27
    v_exp_f32 v28, v28
    v_smfmac_f32_32x32x32_bf16 v[80:95], v[172:175], v[16:23], v154
    v_exp_f32 v29, v29
    v_exp_f32 v30, v30
    s_mov_b64 exec, s[30:31]
    ds_read_b128 v[180:183], v189 offset:6400
    ds_read_b128 v[184:187], v189 offset:7040
    s_mov_b64 exec, -1
    v_exp_f32 v31, v31
    v_exp_f32 v32, v32
    v_exp_f32 v33, v33
    v_smfmac_f32_32x32x32_bf16 v[80:95], v[176:179], v[24:31], v154
    v_exp_f32 v34, v34
    v_exp_f32 v35, v35
    ds_read_b128 v[156:159], v188 offset:2048
    v_exp_f32 v36, v36
    v_exp_f32 v37, v37
    v_mfma_f32_32x32x16_bf16 v[48:63], v[160:163], v[144:147], v[48:63]
    v_exp_f32 v38, v38
    v_exp_f32 v39, v39
    v_exp_f32 v40, v40
    v_exp_f32 v41, v41
    v_smfmac_f32_32x32x32_bf16 v[96:111], v[172:175], v[32:39], v154
    v_exp_f32 v42, v42
    v_exp_f32 v43, v43
    v_exp_f32 v44, v44
    v_mfma_f32_32x32x16_bf16 v[64:79], v[160:163], v[148:151], v[64:79]
    v_exp_f32 v45, v45
    v_exp_f32 v46, v46
    v_exp_f32 v47, v47
    v_exp_f32 v48, v48
    v_exp_f32 v49, v49
    v_smfmac_f32_32x32x32_bf16 v[96:111], v[176:179], v[40:47], v154
    s_waitcnt lgkmcnt(0)
    v_exp_f32 v50, v50
    v_exp_f32 v51, v51
    v_exp_f32 v52, v52
    v_mfma_f32_32x32x4_2b_bf16 v[16:47], v[166:167], v[152:153], v[112:143] cbsz:1 abid:0
    v_exp_f32 v53, v53
    v_exp_f32 v54, v54
    v_exp_f32 v55, v55
    v_exp_f32 v56, v56
    v_exp_f32 v57, v57
    v_exp_f32 v58, v58
    v_exp_f32 v59, v59
    v_exp_f32 v60, v60
    v_smfmac_f32_32x32x32_bf16 v[80:95], v[180:183], v[48:55], v154
    v_exp_f32 v61, v61
    v_exp_f32 v62, v62
    s_mov_b64 exec, s[30:31]
    ds_read_b128 v[172:175], v189 offset:7680
    ds_read_b128 v[176:179], v189 offset:8320
    s_mov_b64 exec, -1
    v_exp_f32 v63, v63
    v_exp_f32 v64, v64
    v_exp_f32 v65, v65
    v_smfmac_f32_32x32x32_bf16 v[80:95], v[184:187], v[56:63], v154
    v_exp_f32 v66, v66
    v_exp_f32 v67, v67
    ds_read_b128 v[160:163], v188 offset:3072
    v_exp_f32 v68, v68
    v_exp_f32 v69, v69
    v_mfma_f32_32x32x16_bf16 v[16:31], v[156:159], v[144:147], v[16:31]
    v_exp_f32 v70, v70
    v_exp_f32 v71, v71
    v_exp_f32 v72, v72
    v_exp_f32 v73, v73
    v_smfmac_f32_32x32x32_bf16 v[96:111], v[180:183], v[64:71], v154
    v_exp_f32 v74, v74
    v_exp_f32 v75, v75
    v_exp_f32 v76, v76
    v_mfma_f32_32x32x16_bf16 v[32:47], v[156:159], v[148:151], v[32:47]
    v_exp_f32 v77, v77
    v_exp_f32 v78, v78
    v_exp_f32 v79, v79
    v_exp_f32 v16, v16
    v_exp_f32 v17, v17
    v_smfmac_f32_32x32x32_bf16 v[96:111], v[184:187], v[72:79], v154
    s_waitcnt lgkmcnt(0)
    v_exp_f32 v18, v18
    v_exp_f32 v19, v19
    v_exp_f32 v20, v20
    v_mfma_f32_32x32x4_2b_bf16 v[48:79], v[166:167], v[152:153], v[112:143] cbsz:1 abid:1
    v_exp_f32 v21, v21
    v_exp_f32 v22, v22
    v_exp_f32 v23, v23
    v_exp_f32 v24, v24
    v_exp_f32 v25, v25
    v_exp_f32 v26, v26
    v_exp_f32 v27, v27
    v_exp_f32 v28, v28
    v_smfmac_f32_32x32x32_bf16 v[80:95], v[172:175], v[16:23], v154
    v_exp_f32 v29, v29
    v_exp_f32 v30, v30
    s_mov_b64 exec, s[30:31]
    ds_read_b128 v[180:183], v189 offset:8960
    ds_read_b128 v[184:187], v189 offset:9600
    s_mov_b64 exec, -1
    v_exp_f32 v31, v31
    v_exp_f32 v32, v32
    v_exp_f32 v33, v33
    v_smfmac_f32_32x32x32_bf16 v[80:95], v[176:179], v[24:31], v154
    v_exp_f32 v34, v34
    v_exp_f32 v35, v35
    ds_read_b128 v[156:159], v188 offset:10240
    ds_read_b128 v[164:167], v188 offset:14336
    v_exp_f32 v36, v36
    v_exp_f32 v37, v37
    v_mfma_f32_32x32x16_bf16 v[48:63], v[160:163], v[144:147], v[48:63]
    v_exp_f32 v38, v38
    v_exp_f32 v39, v39
    v_exp_f32 v40, v40
    v_exp_f32 v41, v41
    v_smfmac_f32_32x32x32_bf16 v[96:111], v[172:175], v[32:39], v154
    v_exp_f32 v42, v42
    v_exp_f32 v43, v43
    v_exp_f32 v44, v44
    v_mfma_f32_32x32x16_bf16 v[64:79], v[160:163], v[148:151], v[64:79]
    v_exp_f32 v45, v45
    v_exp_f32 v46, v46
    v_exp_f32 v47, v47
    v_exp_f32 v48, v48
    v_exp_f32 v49, v49
    v_smfmac_f32_32x32x32_bf16 v[96:111], v[176:179], v[40:47], v154
    s_waitcnt lgkmcnt(0)
    v_exp_f32 v50, v50
    v_exp_f32 v51, v51
    v_exp_f32 v52, v52
    v_mfma_f32_32x32x4_2b_bf16 v[16:47], v[164:165], v[152:153], v[112:143] cbsz:1 abid:0
    v_exp_f32 v53, v53
    v_exp_f32 v54, v54
    v_exp_f32 v55, v55
    v_exp_f32 v56, v56
    v_exp_f32 v57, v57
    v_exp_f32 v58, v58
    v_exp_f32 v59, v59
    v_exp_f32 v60, v60
    v_smfmac_f32_32x32x32_bf16 v[80:95], v[180:183], v[48:55], v154
    v_exp_f32 v61, v61
    v_exp_f32 v62, v62
    s_mov_b64 exec, s[30:31]
    ds_read_b128 v[172:175], v189 offset:15360
    ds_read_b128 v[176:179], v189 offset:16000
    s_mov_b64 exec, -1
    v_exp_f32 v63, v63
    v_exp_f32 v64, v64
    v_exp_f32 v65, v65
    v_smfmac_f32_32x32x32_bf16 v[80:95], v[184:187], v[56:63], v154
    v_exp_f32 v66, v66
    v_exp_f32 v67, v67
    ds_read_b128 v[160:163], v188 offset:11264
    v_add_u32 v188, s29, v188
    v_add_u32 v189, s29, v189
    v_exp_f32 v68, v68
    v_exp_f32 v69, v69
    v_mfma_f32_32x32x16_bf16 v[16:31], v[156:159], v[144:147], v[16:31]
    v_exp_f32 v70, v70
    v_exp_f32 v71, v71
    v_exp_f32 v72, v72
    v_exp_f32 v73, v73
    v_smfmac_f32_32x32x32_bf16 v[96:111], v[180:183], v[64:71], v154
    v_exp_f32 v74, v74
    v_exp_f32 v75, v75
    v_exp_f32 v76, v76
    v_mfma_f32_32x32x16_bf16 v[32:47], v[156:159], v[148:151], v[32:47]
    v_exp_f32 v77, v77
    v_exp_f32 v78, v78
    v_exp_f32 v79, v79
    s_add_u32 s34, s34, 1
    s_bitcmp1_b32 s35, s34
    s_cbranch_scc0 L_loop
    s_cmp_lt_u32 s34, 15
    s_cbranch_scc1 L_event
    v_exp_f32 v16, v16
    v_exp_f32 v17, v17
    v_smfmac_f32_32x32x32_bf16 v[96:111], v[184:187], v[72:79], v154
    s_waitcnt lgkmcnt(0)
    v_exp_f32 v18, v18
    v_exp_f32 v19, v19
    v_exp_f32 v20, v20
    v_mfma_f32_32x32x4_2b_bf16 v[48:79], v[164:165], v[152:153], v[112:143] cbsz:1 abid:1
    v_exp_f32 v21, v21
    v_exp_f32 v22, v22
    v_exp_f32 v23, v23
    v_exp_f32 v24, v24
    v_exp_f32 v25, v25
    v_exp_f32 v26, v26
    v_exp_f32 v27, v27
    v_exp_f32 v28, v28
    v_smfmac_f32_32x32x32_bf16 v[80:95], v[172:175], v[16:23], v154
    v_exp_f32 v29, v29
    v_exp_f32 v30, v30
    s_mov_b64 exec, s[30:31]
    ds_read_b128 v[180:183], v189 offset:6400
    ds_read_b128 v[184:187], v189 offset:7040
    s_mov_b64 exec, -1
    v_exp_f32 v31, v31
    v_exp_f32 v32, v32
    v_exp_f32 v33, v33
    v_smfmac_f32_32x32x32_bf16 v[80:95], v[176:179], v[24:31], v154
    v_exp_f32 v34, v34
    v_exp_f32 v35, v35
    ds_read_b128 v[156:159], v188 offset:2048
    v_exp_f32 v36, v36
    v_exp_f32 v37, v37
    v_mfma_f32_32x32x16_bf16 v[48:63], v[160:163], v[144:147], v[48:63]
    v_exp_f32 v38, v38
    v_exp_f32 v39, v39
    v_exp_f32 v40, v40
    v_exp_f32 v41, v41
    v_smfmac_f32_32x32x32_bf16 v[96:111], v[172:175], v[32:39], v154
    v_exp_f32 v42, v42
    v_exp_f32 v43, v43
    v_exp_f32 v44, v44
    v_mfma_f32_32x32x16_bf16 v[64:79], v[160:163], v[148:151], v[64:79]
    v_exp_f32 v45, v45
    v_exp_f32 v46, v46
    v_exp_f32 v47, v47
    v_exp_f32 v48, v48
    v_exp_f32 v49, v49
    v_smfmac_f32_32x32x32_bf16 v[96:111], v[176:179], v[40:47], v154
    s_waitcnt lgkmcnt(0)
    v_exp_f32 v50, v50
    v_exp_f32 v51, v51
    v_exp_f32 v52, v52
    v_mfma_f32_32x32x4_2b_bf16 v[16:47], v[166:167], v[152:153], v[112:143] cbsz:1 abid:0
    v_exp_f32 v53, v53
    v_exp_f32 v54, v54
    v_exp_f32 v55, v55
    v_exp_f32 v56, v56
    v_exp_f32 v57, v57
    v_exp_f32 v58, v58
    v_exp_f32 v59, v59
    v_exp_f32 v60, v60
    v_smfmac_f32_32x32x32_bf16 v[80:95], v[180:183], v[48:55], v154
    v_exp_f32 v61, v61
    v_exp_f32 v62, v62
    s_mov_b64 exec, s[30:31]
    ds_read_b128 v[172:175], v189 offset:7680
    ds_read_b128 v[176:179], v189 offset:8320
    s_mov_b64 exec, -1
    v_exp_f32 v63, v63
    v_exp_f32 v64, v64
    v_exp_f32 v65, v65
    v_smfmac_f32_32x32x32_bf16 v[80:95], v[184:187], v[56:63], v154
    v_exp_f32 v66, v66
    v_exp_f32 v67, v67
    ds_read_b128 v[160:163], v188 offset:3072
    v_exp_f32 v68, v68
    v_exp_f32 v69, v69
    v_mfma_f32_32x32x16_bf16 v[16:31], v[156:159], v[144:147], v[16:31]
    v_exp_f32 v70, v70
    v_exp_f32 v71, v71
    v_exp_f32 v72, v72
    v_exp_f32 v73, v73
    v_smfmac_f32_32x32x32_bf16 v[96:111], v[180:183], v[64:71], v154
    v_exp_f32 v74, v74
    v_exp_f32 v75, v75
    v_exp_f32 v76, v76
    v_mfma_f32_32x32x16_bf16 v[32:47], v[156:159], v[148:151], v[32:47]
    v_exp_f32 v77, v77
    v_exp_f32 v78, v78
    v_exp_f32 v79, v79
    v_exp_f32 v16, v16
    v_exp_f32 v17, v17
    v_smfmac_f32_32x32x32_bf16 v[96:111], v[184:187], v[72:79], v154
    s_waitcnt lgkmcnt(0)
    v_exp_f32 v18, v18
    v_exp_f32 v19, v19
    v_exp_f32 v20, v20
    v_mfma_f32_32x32x4_2b_bf16 v[48:79], v[166:167], v[152:153], v[112:143] cbsz:1 abid:1
    v_exp_f32 v21, v21
    v_exp_f32 v22, v22
    v_exp_f32 v23, v23
    v_exp_f32 v24, v24
    v_exp_f32 v25, v25
    v_exp_f32 v26, v26
    v_exp_f32 v27, v27
    v_exp_f32 v28, v28
    v_smfmac_f32_32x32x32_bf16 v[80:95], v[172:175], v[16:23], v154
    v_exp_f32 v29, v29
    v_exp_f32 v30, v30
    s_mov_b64 exec, s[30:31]
    ds_read_b128 v[180:183], v189 offset:8960
    ds_read_b128 v[184:187], v189 offset:9600
    s_mov_b64 exec, -1
    v_exp_f32 v31, v31
    v_exp_f32 v32, v32
    v_exp_f32 v33, v33
    v_smfmac_f32_32x32x32_bf16 v[80:95], v[176:179], v[24:31], v154
    v_exp_f32 v34, v34
    v_exp_f32 v35, v35
    v_exp_f32 v36, v36
    v_exp_f32 v37, v37
    v_mfma_f32_32x32x16_bf16 v[48:63], v[160:163], v[144:147], v[48:63]
    v_exp_f32 v38, v38
    v_exp_f32 v39, v39
    v_exp_f32 v40, v40
    v_exp_f32 v41, v41
    v_smfmac_f32_32x32x32_bf16 v[96:111], v[172:175], v[32:39], v154
    v_exp_f32 v42, v42
    v_exp_f32 v43, v43
    v_exp_f32 v44, v44
    v_mfma_f32_32x32x16_bf16 v[64:79], v[160:163], v[148:151], v[64:79]
    v_exp_f32 v45, v45
    v_exp_f32 v46, v46
    v_exp_f32 v47, v47
    v_exp_f32 v48, v48
    v_exp_f32 v49, v49
    s_add_u32 s33, s27, 16384
    buffer_load_dwordx4 v[112:115], v1, s[8:11], s33 offen offset:0 sc1
    v_smfmac_f32_32x32x32_bf16 v[96:111], v[176:179], v[40:47], v154
    s_waitcnt lgkmcnt(0)
    v_exp_f32 v50, v50
    v_exp_f32 v51, v51
    v_exp_f32 v52, v52
    buffer_load_dwordx4 v[116:119], v1, s[8:11], s33 offen offset:1024 sc1
    v_exp_f32 v53, v53
    v_exp_f32 v54, v54
    v_exp_f32 v55, v55
    buffer_load_dwordx4 v[120:123], v1, s[8:11], s33 offen offset:2048 sc1
    v_exp_f32 v56, v56
    v_exp_f32 v57, v57
    v_exp_f32 v58, v58
    buffer_load_dwordx4 v[124:127], v1, s[8:11], s33 offen offset:3072 sc1
    v_exp_f32 v59, v59
    v_exp_f32 v60, v60
    v_smfmac_f32_32x32x32_bf16 v[80:95], v[180:183], v[48:55], v154
    v_exp_f32 v61, v61
    s_add_u32 s33, s27, 20480
    buffer_load_dwordx4 v[128:131], v1, s[8:11], s33 offen offset:0 sc1
    v_exp_f32 v62, v62
    v_exp_f32 v63, v63
    v_exp_f32 v64, v64
    buffer_load_dwordx4 v[132:135], v1, s[8:11], s33 offen offset:1024 sc1
    v_exp_f32 v65, v65
    v_smfmac_f32_32x32x32_bf16 v[80:95], v[184:187], v[56:63], v154
    v_exp_f32 v66, v66
    v_exp_f32 v67, v67
    buffer_load_dwordx4 v[136:139], v1, s[8:11], s33 offen offset:2048 sc1
    v_exp_f32 v68, v68
    v_exp_f32 v69, v69
    v_exp_f32 v70, v70
    buffer_load_dwordx4 v[140:143], v1, s[8:11], s33 offen offset:3072 sc1
    v_exp_f32 v71, v71
    v_exp_f32 v72, v72
    v_exp_f32 v73, v73
    v_smfmac_f32_32x32x32_bf16 v[96:111], v[180:183], v[64:71], v154
    v_exp_f32 v74, v74
    v_exp_f32 v75, v75
    v_exp_f32 v76, v76
    v_exp_f32 v77, v77
    v_exp_f32 v78, v78
    v_exp_f32 v79, v79
    s_nop 1
    v_smfmac_f32_32x32x32_bf16 v[96:111], v[184:187], v[72:79], v154
    s_setprio 0
    s_waitcnt vmcnt(8)
    s_getreg_b32 s33, hwreg(HW_REG_XCC_ID, 0, 4)
    s_nop 0
    v_cmp_ne_u32 vcc, s33, v11
    s_cmp_eq_u64 vcc, 0
    s_cselect_b32 s25, 1, 0
    s_lshl_b32 s26, s21, 3
    s_add_u32 s34, s26, s22
    s_mul_i32 s34, s34, 20480
    s_add_u32 s26, s26, s20
    s_mul_i32 s26, s26, 20480
    s_add_u32 s26, s26, 393216
    s_mul_i32 s33, s47, 10240
    s_add_u32 s34, s34, s33
    s_add_u32 s34, s34, 393216
    s_lshl_b32 s35, s46, 10
    s_add_u32 s35, s35, s34
    s_lshl_b32 s28, s46, 8
    s_add_u32 s28, s28, s34
    s_add_u32 s28, s28, 4096
    v_and_b32 v12, 15, v2
    v_bfe_u32 v13, v2, 4, 1
    v_mul_u32_u24 v13, 5120, v13
    v_lshl_add_u32 v14, v12, 4, v13
    v_lshl_add_u32 v15, v4, 8, v14
    v_rcp_f32 v12, v92
    v_rcp_f32 v13, v108
    s_nop 0
    v_mul_f32 v12, v12, v10
    v_mul_f32 v13, v13, v10
    v_mul_f32 v80, v80, v12
    v_mul_f32 v81, v81, v12
    v_mul_f32 v82, v82, v12
    v_mul_f32 v83, v83, v12
    v_mul_f32 v84, v84, v12
    v_mul_f32 v85, v85, v12
    v_mul_f32 v86, v86, v12
    v_mul_f32 v87, v87, v12
    v_mul_f32 v88, v88, v12
    v_mul_f32 v89, v89, v12
    v_mul_f32 v90, v90, v12
    v_mul_f32 v91, v91, v12
    v_cvt_pk_bf16_f32 v172, v80, v81
    v_cvt_pk_bf16_f32 v173, v82, v83
    v_cvt_pk_bf16_f32 v174, v84, v85
    v_cvt_pk_bf16_f32 v175, v86, v87
    v_cvt_pk_bf16_f32 v180, v88, v89
    v_cvt_pk_bf16_f32 v181, v90, v91
    v_mul_f32 v96, v96, v13
    v_mul_f32 v97, v97, v13
    v_mul_f32 v98, v98, v13
    v_mul_f32 v99, v99, v13
    v_mul_f32 v100, v100, v13
    v_mul_f32 v101, v101, v13
    v_mul_f32 v102, v102, v13
    v_mul_f32 v103, v103, v13
    v_mul_f32 v104, v104, v13
    v_mul_f32 v105, v105, v13
    v_mul_f32 v106, v106, v13
    v_mul_f32 v107, v107, v13
    v_cvt_pk_bf16_f32 v176, v96, v97
    v_cvt_pk_bf16_f32 v177, v98, v99
    v_cvt_pk_bf16_f32 v178, v100, v101
    v_cvt_pk_bf16_f32 v179, v102, v103
    v_cvt_pk_bf16_f32 v182, v104, v105
    v_cvt_pk_bf16_f32 v183, v106, v107
    s_cmp_eq_u32 s25, 0
    s_cbranch_scc1 L_st1
    buffer_store_dwordx4 v[172:175], v15, s[8:11], s35 offen offset:0
    buffer_store_dwordx4 v[176:179], v15, s[8:11], s35 offen offset:512
    s_mov_b32 exec_hi, 0
    buffer_store_dwordx4 v[180:183], v14, s[8:11], s28 offen
    s_branch L_st2
L_st1:
    buffer_store_dwordx4 v[172:175], v15, s[8:11], s35 offen offset:0 sc1
    buffer_store_dwordx4 v[176:179], v15, s[8:11], s35 offen offset:512 sc1
    s_mov_b32 exec_hi, 0
    buffer_store_dwordx4 v[180:183], v14, s[8:11], s28 offen sc1
L_st2:
    s_mov_b64 exec, -1
    s_mul_i32 s28, s20, 20480
    v_add_u32 v5, s28, v1
    s_add_u32 s33, s22, 0
    s_and_b32 s33, s33, 3
    s_mul_i32 s33, s33, 5120
    v_add_u32 v6, s33, v5
    s_add_u32 s40, s26, s33
    s_add_u32 s41, s40, 1024
    s_add_u32 s33, s22, 1
    s_and_b32 s33, s33, 3
    s_mul_i32 s33, s33, 5120
    v_add_u32 v7, s33, v5
    s_add_u32 s42, s26, s33
    s_add_u32 s43, s42, 1024
    s_add_u32 s33, s22, 2
    s_and_b32 s33, s33, 3
    s_mul_i32 s33, s33, 5120
    v_add_u32 v8, s33, v5
    s_add_u32 s44, s26, s33
    s_add_u32 s45, s44, 1024
    s_add_u32 s33, s22, 3
    s_and_b32 s33, s33, 3
    s_mul_i32 s33, s33, 5120
    v_add_u32 v9, s33, v5
    s_add_u32 s46, s26, s33
    s_add_u32 s47, s46, 1024
    s_mov_b32 s12, s58
    s_mov_b32 s13, s59
    s_mov_b32 s14, 2621440
    s_mov_b32 s15, 0x00020000
    s_lshl_b32 s30, s21, 9
    s_add_u32 s30, s30, 360704
    s_lshl_b32 s31, s22, 5
    s_add_u32 s31, s31, s30
    s_lshl_b32 s33, s20, 2
    s_add_u32 s31, s31, s33
    s_lshl_b32 s33, s20, 5
    s_add_u32 s30, s30, s33
    v_lshlrev_b32 v15, 2, v2
    v_mov_b32 v14, 1
    s_mov_b64 exec, 1
    s_cmp_eq_u32 s25, 0
    s_waitcnt vmcnt(0)
    s_cbranch_scc1 L_fl1
    buffer_store_dword v14, v15, s[8:11], s31 offen
    s_branch L_fl2
L_fl1:
    buffer_store_dword v14, v15, s[8:11], s31 offen sc1
    s_waitcnt vmcnt(0)
L_fl2:
    s_barrier
    s_mov_b32 s33, 0
    s_mov_b64 exec, 0xff
L_poll2:
    buffer_load_dword v14, v15, s[8:11], s30 offen sc1
    s_add_u32 s33, s33, 1
    s_waitcnt vmcnt(0)
    v_cmp_ne_u32 vcc, 1, v14
    s_cmp_eq_u64 vcc, 0
    s_cbranch_scc1 L_p2ok
    s_cmp_ge_u32 s33, 60000
    s_cbranch_scc1 L_p2ok
    s_sleep 2
    s_branch L_poll2
L_p2ok:
    s_mov_b64 exec, -1
    buffer_load_dwordx4 v[52:55], v1, s[8:11], s40 offen sc1
    buffer_load_dwordx4 v[56:59], v1, s[8:11], s41 offen offset:0 sc1
    buffer_load_dwordx4 v[60:63], v1, s[8:11], s41 offen offset:1024 sc1
    buffer_load_dwordx4 v[64:67], v1, s[8:11], s41 offen offset:2048 sc1
    s_setprio 3
    s_waitcnt vmcnt(3)
    v_mfma_f32_16x16x32_bf16 v[12:15], v[192:195], v[52:55], 0
    buffer_load_dwordx4 v[68:71], v1, s[8:11], s41 offen offset:3072 sc1
    v_mfma_f32_16x16x32_bf16 v[16:19], v[196:199], v[52:55], 0
    v_mfma_f32_16x16x32_bf16 v[20:23], v[200:203], v[52:55], 0
    v_mfma_f32_16x16x32_bf16 v[24:27], v[204:207], v[52:55], 0
    v_mfma_f32_16x16x32_bf16 v[28:31], v[208:211], v[52:55], 0
    s_waitcnt vmcnt(3)
    v_mfma_f32_16x16x32_bf16 v[12:15], v[212:215], v[56:59], v[12:15]
    buffer_load_dwordx4 v[72:75], v1, s[8:11], s42 offen sc1
    v_mfma_f32_16x16x32_bf16 v[16:19], v[216:219], v[56:59], v[16:19]
    v_mfma_f32_16x16x32_bf16 v[20:23], v[220:223], v[56:59], v[20:23]
    v_mfma_f32_16x16x32_bf16 v[24:27], v[224:227], v[56:59], v[24:27]
    v_mfma_f32_16x16x32_bf16 v[28:31], v[228:231], v[56:59], v[28:31]
    s_waitcnt vmcnt(3)
    v_mfma_f32_16x16x32_bf16 v[12:15], v[232:235], v[60:63], v[12:15]
    buffer_load_dwordx4 v[76:79], v1, s[8:11], s43 offen offset:0 sc1
    v_mfma_f32_16x16x32_bf16 v[16:19], v[236:239], v[60:63], v[16:19]
    v_mfma_f32_16x16x32_bf16 v[20:23], v[240:243], v[60:63], v[20:23]
    v_mfma_f32_16x16x32_bf16 v[24:27], v[244:247], v[60:63], v[24:27]
    v_mfma_f32_16x16x32_bf16 v[28:31], v[248:251], v[60:63], v[28:31]
    s_waitcnt vmcnt(3)
    v_mfma_f32_16x16x32_bf16 v[12:15], v[252:255], v[64:67], v[12:15]
    buffer_load_dwordx4 v[80:83], v1, s[8:11], s43 offen offset:1024 sc1
    v_mfma_f32_16x16x32_bf16 v[16:19], v[112:115], v[64:67], v[16:19]
    v_mfma_f32_16x16x32_bf16 v[20:23], v[116:119], v[64:67], v[20:23]
    v_mfma_f32_16x16x32_bf16 v[24:27], v[120:123], v[64:67], v[24:27]
    v_mfma_f32_16x16x32_bf16 v[28:31], v[124:127], v[64:67], v[28:31]
    s_waitcnt vmcnt(3)
    v_mfma_f32_16x16x32_bf16 v[12:15], v[128:131], v[68:71], v[12:15]
    buffer_load_dwordx4 v[84:87], v1, s[8:11], s43 offen offset:2048 sc1
    v_mfma_f32_16x16x32_bf16 v[16:19], v[132:135], v[68:71], v[16:19]
    v_mfma_f32_16x16x32_bf16 v[20:23], v[136:139], v[68:71], v[20:23]
    v_mfma_f32_16x16x32_bf16 v[24:27], v[140:143], v[68:71], v[24:27]
    v_mfma_f32_16x16x32_bf16 v[28:31], v[168:171], v[68:71], v[28:31]
    s_setprio 2
    s_waitcnt vmcnt(3)
    v_mfma_f32_16x16x32_bf16 v[32:35], v[192:195], v[72:75], 0
    buffer_load_dwordx4 v[88:91], v1, s[8:11], s43 offen offset:3072 sc1
    v_mfma_f32_16x16x32_bf16 v[36:39], v[196:199], v[72:75], 0
    v_mfma_f32_16x16x32_bf16 v[40:43], v[200:203], v[72:75], 0
    v_mfma_f32_16x16x32_bf16 v[44:47], v[204:207], v[72:75], 0
    ds_write_b128 v6, v[12:15] offset:0
    v_mfma_f32_16x16x32_bf16 v[48:51], v[208:211], v[72:75], 0
    s_waitcnt vmcnt(3)
    v_mfma_f32_16x16x32_bf16 v[32:35], v[212:215], v[76:79], v[32:35]
    buffer_load_dwordx4 v[92:95], v1, s[8:11], s44 offen sc1
    v_mfma_f32_16x16x32_bf16 v[36:39], v[216:219], v[76:79], v[36:39]
    v_mfma_f32_16x16x32_bf16 v[40:43], v[220:223], v[76:79], v[40:43]
    v_mfma_f32_16x16x32_bf16 v[44:47], v[224:227], v[76:79], v[44:47]
    ds_write_b128 v6, v[16:19] offset:1024
    v_mfma_f32_16x16x32_bf16 v[48:51], v[228:231], v[76:79], v[48:51]
    s_waitcnt vmcnt(3)
    v_mfma_f32_16x16x32_bf16 v[32:35], v[232:235], v[80:83], v[32:35]
    buffer_load_dwordx4 v[96:99], v1, s[8:11], s45 offen offset:0 sc1
    v_mfma_f32_16x16x32_bf16 v[36:39], v[236:239], v[80:83], v[36:39]
    v_mfma_f32_16x16x32_bf16 v[40:43], v[240:243], v[80:83], v[40:43]
    v_mfma_f32_16x16x32_bf16 v[44:47], v[244:247], v[80:83], v[44:47]
    ds_write_b128 v6, v[20:23] offset:2048
    v_mfma_f32_16x16x32_bf16 v[48:51], v[248:251], v[80:83], v[48:51]
    s_waitcnt vmcnt(3)
    v_mfma_f32_16x16x32_bf16 v[32:35], v[252:255], v[84:87], v[32:35]
    buffer_load_dwordx4 v[100:103], v1, s[8:11], s45 offen offset:1024 sc1
    v_mfma_f32_16x16x32_bf16 v[36:39], v[112:115], v[84:87], v[36:39]
    v_mfma_f32_16x16x32_bf16 v[40:43], v[116:119], v[84:87], v[40:43]
    v_mfma_f32_16x16x32_bf16 v[44:47], v[120:123], v[84:87], v[44:47]
    ds_write_b128 v6, v[24:27] offset:3072
    v_mfma_f32_16x16x32_bf16 v[48:51], v[124:127], v[84:87], v[48:51]
    s_waitcnt vmcnt(3)
    v_mfma_f32_16x16x32_bf16 v[32:35], v[128:131], v[88:91], v[32:35]
    buffer_load_dwordx4 v[104:107], v1, s[8:11], s45 offen offset:2048 sc1
    v_mfma_f32_16x16x32_bf16 v[36:39], v[132:135], v[88:91], v[36:39]
    v_mfma_f32_16x16x32_bf16 v[40:43], v[136:139], v[88:91], v[40:43]
    v_mfma_f32_16x16x32_bf16 v[44:47], v[140:143], v[88:91], v[44:47]
    ds_write_b128 v6, v[28:31] offset:4096
    v_mfma_f32_16x16x32_bf16 v[48:51], v[168:171], v[88:91], v[48:51]
    s_setprio 1
    s_waitcnt vmcnt(3)
    v_mfma_f32_16x16x32_bf16 v[12:15], v[192:195], v[92:95], 0
    buffer_load_dwordx4 v[108:111], v1, s[8:11], s45 offen offset:3072 sc1
    v_mfma_f32_16x16x32_bf16 v[16:19], v[196:199], v[92:95], 0
    v_mfma_f32_16x16x32_bf16 v[20:23], v[200:203], v[92:95], 0
    v_mfma_f32_16x16x32_bf16 v[24:27], v[204:207], v[92:95], 0
    ds_write_b128 v7, v[32:35] offset:0
    v_mfma_f32_16x16x32_bf16 v[28:31], v[208:211], v[92:95], 0
    s_waitcnt vmcnt(3)
    v_mfma_f32_16x16x32_bf16 v[12:15], v[212:215], v[96:99], v[12:15]
    buffer_load_dwordx4 v[144:147], v1, s[8:11], s46 offen sc1
    v_mfma_f32_16x16x32_bf16 v[16:19], v[216:219], v[96:99], v[16:19]
    v_mfma_f32_16x16x32_bf16 v[20:23], v[220:223], v[96:99], v[20:23]
    v_mfma_f32_16x16x32_bf16 v[24:27], v[224:227], v[96:99], v[24:27]
    ds_write_b128 v7, v[36:39] offset:1024
    v_mfma_f32_16x16x32_bf16 v[28:31], v[228:231], v[96:99], v[28:31]
    s_waitcnt vmcnt(3)
    v_mfma_f32_16x16x32_bf16 v[12:15], v[232:235], v[100:103], v[12:15]
    buffer_load_dwordx4 v[148:151], v1, s[8:11], s47 offen offset:0 sc1
    v_mfma_f32_16x16x32_bf16 v[16:19], v[236:239], v[100:103], v[16:19]
    v_mfma_f32_16x16x32_bf16 v[20:23], v[240:243], v[100:103], v[20:23]
    v_mfma_f32_16x16x32_bf16 v[24:27], v[244:247], v[100:103], v[24:27]
    ds_write_b128 v7, v[40:43] offset:2048
    v_mfma_f32_16x16x32_bf16 v[28:31], v[248:251], v[100:103], v[28:31]
    s_waitcnt vmcnt(3)
    v_mfma_f32_16x16x32_bf16 v[12:15], v[252:255], v[104:107], v[12:15]
    buffer_load_dwordx4 v[152:155], v1, s[8:11], s47 offen offset:1024 sc1
    v_mfma_f32_16x16x32_bf16 v[16:19], v[112:115], v[104:107], v[16:19]
    v_mfma_f32_16x16x32_bf16 v[20:23], v[116:119], v[104:107], v[20:23]
    v_mfma_f32_16x16x32_bf16 v[24:27], v[120:123], v[104:107], v[24:27]
    ds_write_b128 v7, v[44:47] offset:3072
    v_mfma_f32_16x16x32_bf16 v[28:31], v[124:127], v[104:107], v[28:31]
    s_waitcnt vmcnt(3)
    v_mfma_f32_16x16x32_bf16 v[12:15], v[128:131], v[108:111], v[12:15]
    buffer_load_dwordx4 v[156:159], v1, s[8:11], s47 offen offset:2048 sc1
    v_mfma_f32_16x16x32_bf16 v[16:19], v[132:135], v[108:111], v[16:19]
    v_mfma_f32_16x16x32_bf16 v[20:23], v[136:139], v[108:111], v[20:23]
    v_mfma_f32_16x16x32_bf16 v[24:27], v[140:143], v[108:111], v[24:27]
    ds_write_b128 v7, v[48:51] offset:4096
    v_mfma_f32_16x16x32_bf16 v[28:31], v[168:171], v[108:111], v[28:31]
    s_setprio 0
    s_waitcnt vmcnt(3)
    v_mfma_f32_16x16x32_bf16 v[32:35], v[192:195], v[144:147], 0
    buffer_load_dwordx4 v[160:163], v1, s[8:11], s47 offen offset:3072 sc1
    v_mfma_f32_16x16x32_bf16 v[36:39], v[196:199], v[144:147], 0
    v_mfma_f32_16x16x32_bf16 v[40:43], v[200:203], v[144:147], 0
    v_mfma_f32_16x16x32_bf16 v[44:47], v[204:207], v[144:147], 0
    ds_write_b128 v8, v[12:15] offset:0
    v_mfma_f32_16x16x32_bf16 v[48:51], v[208:211], v[144:147], 0
    s_waitcnt vmcnt(3)
    v_mfma_f32_16x16x32_bf16 v[32:35], v[212:215], v[148:151], v[32:35]
    v_mfma_f32_16x16x32_bf16 v[36:39], v[216:219], v[148:151], v[36:39]
    v_mfma_f32_16x16x32_bf16 v[40:43], v[220:223], v[148:151], v[40:43]
    v_mfma_f32_16x16x32_bf16 v[44:47], v[224:227], v[148:151], v[44:47]
    ds_write_b128 v8, v[16:19] offset:1024
    v_mfma_f32_16x16x32_bf16 v[48:51], v[228:231], v[148:151], v[48:51]
    s_waitcnt vmcnt(2)
    v_mfma_f32_16x16x32_bf16 v[32:35], v[232:235], v[152:155], v[32:35]
    v_mfma_f32_16x16x32_bf16 v[36:39], v[236:239], v[152:155], v[36:39]
    v_mfma_f32_16x16x32_bf16 v[40:43], v[240:243], v[152:155], v[40:43]
    v_mfma_f32_16x16x32_bf16 v[44:47], v[244:247], v[152:155], v[44:47]
    ds_write_b128 v8, v[20:23] offset:2048
    v_mfma_f32_16x16x32_bf16 v[48:51], v[248:251], v[152:155], v[48:51]
    s_waitcnt vmcnt(1)
    v_mfma_f32_16x16x32_bf16 v[32:35], v[252:255], v[156:159], v[32:35]
    v_mfma_f32_16x16x32_bf16 v[36:39], v[112:115], v[156:159], v[36:39]
    v_mfma_f32_16x16x32_bf16 v[40:43], v[116:119], v[156:159], v[40:43]
    v_mfma_f32_16x16x32_bf16 v[44:47], v[120:123], v[156:159], v[44:47]
    ds_write_b128 v8, v[24:27] offset:3072
    v_mfma_f32_16x16x32_bf16 v[48:51], v[124:127], v[156:159], v[48:51]
    s_waitcnt vmcnt(0)
    v_mfma_f32_16x16x32_bf16 v[32:35], v[128:131], v[160:163], v[32:35]
    v_mfma_f32_16x16x32_bf16 v[36:39], v[132:135], v[160:163], v[36:39]
    v_mfma_f32_16x16x32_bf16 v[40:43], v[136:139], v[160:163], v[40:43]
    v_mfma_f32_16x16x32_bf16 v[44:47], v[140:143], v[160:163], v[44:47]
    ds_write_b128 v8, v[28:31] offset:4096
    v_mfma_f32_16x16x32_bf16 v[48:51], v[168:171], v[160:163], v[48:51]
    s_nop 4
    ds_write_b128 v9, v[32:35] offset:0
    ds_write_b128 v9, v[36:39] offset:1024
    ds_write_b128 v9, v[40:43] offset:2048
    ds_write_b128 v9, v[44:47] offset:3072
    ds_write_b128 v9, v[48:51] offset:4096
    v_and_b32 v6, 15, v2
    v_lshrrev_b32 v7, 4, v2
    v_mul_u32_u24 v6, 1280, v6
    v_lshl_add_u32 v6, v7, 3, v6
    s_mul_i32 s26, s21, 81920
    s_mul_i32 s27, s22, 160
    s_add_u32 s26, s26, s27
    s_mov_b32 s28, s20
    s_waitcnt lgkmcnt(0)
    s_barrier
    s_lshl_b32 s33, s20, 10
    v_add_u32 v7, s33, v1
    v_add_u32 v8, 0xa000, v7
    v_add_u32 v9, 0x14000, v7
    v_add_u32 v10, 0x1e000, v7
    ds_read_b128 v[64:67], v7 offset:0
    ds_read_b128 v[68:71], v7 offset:20480
    ds_read_b128 v[72:75], v8 offset:0
    ds_read_b128 v[76:79], v8 offset:20480
    ds_read_b128 v[80:83], v9 offset:0
    ds_read_b128 v[84:87], v9 offset:20480
    ds_read_b128 v[88:91], v10 offset:0
    ds_read_b128 v[92:95], v10 offset:20480
    s_waitcnt lgkmcnt(7)
    ds_read_b128 v[96:99], v7 offset:8192
    ds_read_b128 v[100:103], v7 offset:28672
    ds_read_b128 v[104:107], v8 offset:8192
    ds_read_b128 v[108:111], v8 offset:28672
    ds_read_b128 v[112:115], v9 offset:8192
    ds_read_b128 v[116:119], v9 offset:28672
    ds_read_b128 v[120:123], v10 offset:8192
    ds_read_b128 v[124:127], v10 offset:28672
    s_waitcnt lgkmcnt(8)
    s_add_u32 s28, s20, 0
    s_mul_i32 s33, s28, 52
    s_lshr_b32 s33, s33, 8
    s_mul_i32 s34, s33, 20320
    s_lshl_b32 s35, s28, 5
    s_add_u32 s34, s34, s35
    s_add_u32 s34, s34, s26
    v_add_f32 v64, v64, v68
    v_add_f32 v72, v72, v76
    v_add_f32 v80, v80, v84
    v_add_f32 v88, v88, v92
    v_add_f32 v65, v65, v69
    v_add_f32 v73, v73, v77
    v_add_f32 v81, v81, v85
    v_add_f32 v89, v89, v93
    v_add_f32 v66, v66, v70
    v_add_f32 v74, v74, v78
    v_add_f32 v82, v82, v86
    v_add_f32 v90, v90, v94
    v_add_f32 v67, v67, v71
    v_add_f32 v75, v75, v79
    v_add_f32 v83, v83, v87
    v_add_f32 v91, v91, v95
    v_add_f32 v64, v64, v72
    v_add_f32 v80, v80, v88
    v_add_f32 v65, v65, v73
    v_add_f32 v81, v81, v89
    v_add_f32 v66, v66, v74
    v_add_f32 v82, v82, v90
    v_add_f32 v67, v67, v75
    v_add_f32 v83, v83, v91
    v_add_f32 v64, v64, v80
    v_add_f32 v65, v65, v81
    v_add_f32 v66, v66, v82
    v_add_f32 v67, v67, v83
    v_cvt_pk_bf16_f32 v68, v64, v65
    v_cvt_pk_bf16_f32 v69, v66, v67
    buffer_store_dwordx2 v[68:69], v6, s[12:15], s34 offen
    s_cmp_lt_u32 s20, 4
    s_cbranch_scc0 L_f2
    s_waitcnt lgkmcnt(0)
    ds_read_b128 v[128:131], v7 offset:16384
    ds_read_b128 v[132:135], v7 offset:36864
    ds_read_b128 v[136:139], v8 offset:16384
    ds_read_b128 v[140:143], v8 offset:36864
    ds_read_b128 v[144:147], v9 offset:16384
    ds_read_b128 v[148:151], v9 offset:36864
    ds_read_b128 v[152:155], v10 offset:16384
    ds_read_b128 v[156:159], v10 offset:36864
    s_add_u32 s28, s20, 8
    s_mul_i32 s33, s28, 52
    s_lshr_b32 s33, s33, 8
    s_mul_i32 s34, s33, 20320
    s_lshl_b32 s35, s28, 5
    s_add_u32 s34, s34, s35
    s_add_u32 s34, s34, s26
    v_add_f32 v96, v96, v100
    v_add_f32 v104, v104, v108
    v_add_f32 v112, v112, v116
    v_add_f32 v120, v120, v124
    v_add_f32 v97, v97, v101
    v_add_f32 v105, v105, v109
    v_add_f32 v113, v113, v117
    v_add_f32 v121, v121, v125
    v_add_f32 v98, v98, v102
    v_add_f32 v106, v106, v110
    v_add_f32 v114, v114, v118
    v_add_f32 v122, v122, v126
    v_add_f32 v99, v99, v103
    v_add_f32 v107, v107, v111
    v_add_f32 v115, v115, v119
    v_add_f32 v123, v123, v127
    v_add_f32 v96, v96, v104
    v_add_f32 v112, v112, v120
    v_add_f32 v97, v97, v105
    v_add_f32 v113, v113, v121
    v_add_f32 v98, v98, v106
    v_add_f32 v114, v114, v122
    v_add_f32 v99, v99, v107
    v_add_f32 v115, v115, v123
    v_add_f32 v96, v96, v112
    v_add_f32 v97, v97, v113
    v_add_f32 v98, v98, v114
    v_add_f32 v99, v99, v115
    v_cvt_pk_bf16_f32 v100, v96, v97
    v_cvt_pk_bf16_f32 v101, v98, v99
    buffer_store_dwordx2 v[100:101], v6, s[12:15], s34 offen
    s_waitcnt lgkmcnt(0)
    s_add_u32 s28, s20, 16
    s_mul_i32 s33, s28, 52
    s_lshr_b32 s33, s33, 8
    s_mul_i32 s34, s33, 20320
    s_lshl_b32 s35, s28, 5
    s_add_u32 s34, s34, s35
    s_add_u32 s34, s34, s26
    v_add_f32 v128, v128, v132
    v_add_f32 v136, v136, v140
    v_add_f32 v144, v144, v148
    v_add_f32 v152, v152, v156
    v_add_f32 v129, v129, v133
    v_add_f32 v137, v137, v141
    v_add_f32 v145, v145, v149
    v_add_f32 v153, v153, v157
    v_add_f32 v130, v130, v134
    v_add_f32 v138, v138, v142
    v_add_f32 v146, v146, v150
    v_add_f32 v154, v154, v158
    v_add_f32 v131, v131, v135
    v_add_f32 v139, v139, v143
    v_add_f32 v147, v147, v151
    v_add_f32 v155, v155, v159
    v_add_f32 v128, v128, v136
    v_add_f32 v144, v144, v152
    v_add_f32 v129, v129, v137
    v_add_f32 v145, v145, v153
    v_add_f32 v130, v130, v138
    v_add_f32 v146, v146, v154
    v_add_f32 v131, v131, v139
    v_add_f32 v147, v147, v155
    v_add_f32 v128, v128, v144
    v_add_f32 v129, v129, v145
    v_add_f32 v130, v130, v146
    v_add_f32 v131, v131, v147
    v_cvt_pk_bf16_f32 v132, v128, v129
    v_cvt_pk_bf16_f32 v133, v130, v131
    buffer_store_dwordx2 v[132:133], v6, s[12:15], s34 offen
    s_branch L_f3
L_f2:
    s_waitcnt lgkmcnt(0)
    s_add_u32 s28, s20, 8
    s_mul_i32 s33, s28, 52
    s_lshr_b32 s33, s33, 8
    s_mul_i32 s34, s33, 20320
    s_lshl_b32 s35, s28, 5
    s_add_u32 s34, s34, s35
    s_add_u32 s34, s34, s26
    v_add_f32 v96, v96, v100
    v_add_f32 v104, v104, v108
    v_add_f32 v112, v112, v116
    v_add_f32 v120, v120, v124
    v_add_f32 v97, v97, v101
    v_add_f32 v105, v105, v109
    v_add_f32 v113, v113, v117
    v_add_f32 v121, v121, v125
    v_add_f32 v98, v98, v102
    v_add_f32 v106, v106, v110
    v_add_f32 v114, v114, v118
    v_add_f32 v122, v122, v126
    v_add_f32 v99, v99, v103
    v_add_f32 v107, v107, v111
    v_add_f32 v115, v115, v119
    v_add_f32 v123, v123, v127
    v_add_f32 v96, v96, v104
    v_add_f32 v112, v112, v120
    v_add_f32 v97, v97, v105
    v_add_f32 v113, v113, v121
    v_add_f32 v98, v98, v106
    v_add_f32 v114, v114, v122
    v_add_f32 v99, v99, v107
    v_add_f32 v115, v115, v123
    v_add_f32 v96, v96, v112
    v_add_f32 v97, v97, v113
    v_add_f32 v98, v98, v114
    v_add_f32 v99, v99, v115
    v_cvt_pk_bf16_f32 v100, v96, v97
    v_cvt_pk_bf16_f32 v101, v98, v99
    buffer_store_dwordx2 v[100:101], v6, s[12:15], s34 offen
L_f3:
L_end:
    s_endpgm
L_event:
    s_sub_u32 s33, s34, s32
    s_cmp_eq_u32 s33, 0
    s_cbranch_scc1 L_pf
    s_cmp_eq_u32 s33, 1
    s_cbranch_scc1 L_pf1
    s_cmp_eq_u32 s33, 2
    s_cbranch_scc1 L_pf2
    s_cmp_eq_u32 s33, 3
    s_cbranch_scc1 L_pf3
    s_cmp_eq_u32 s34, 12
    s_cbranch_scc1 L_ev2
    s_barrier
    s_branch L_loop
L_ev2:
    s_setprio 0
    s_branch L_loop
L_pf:
    v_lshlrev_b32 v5, 2, v2
    s_mov_b32 s33, 0
L_poll3:
    buffer_load_dword v6, v5, s[72:75], 0 offen sc1
    s_add_u32 s33, s33, 1
    s_waitcnt vmcnt(0)
    s_add_u32 s28, s22, 8
    v_readlane_b32 s4, v6, 0
    v_readlane_b32 s5, v6, 32
    v_readlane_b32 s28, v6, s28
    s_nop 3
    s_min_u32 s4, s4, s5
    s_lshl_b32 s28, s28, 2
    s_min_u32 s4, s4, s28
    s_cmp_ge_u32 s4, 128
    s_cbranch_scc1 L_p3ok
    s_cmp_ge_u32 s33, 60000
    s_cbranch_scc1 L_p3ok
    s_sleep 8
    s_branch L_poll3
L_p3ok:
    s_lshl_b32 s28, s21, 9
    s_add_u32 s28, s28, 360448
    v_and_b32 v5, 7, v2
    v_lshlrev_b32 v5, 2, v5
    buffer_load_dword v11, v5, s[8:11], s28 offen sc1
    v_lshlrev_b32 v5, 2, v2
    buffer_load_dword v6, v5, s[8:11], s28 offen offset:256 sc1
    s_lshl_b32 s28, s23, 13
    s_lshl_b32 s33, s21, 8
    s_add_u32 s28, s28, s33
    s_lshl_b32 s33, s47, 7
    s_add_u32 s28, s28, s33
    s_add_u32 s28, s28, 331776
    buffer_load_dword v10, v191, s[8:11], s28 offen sc1
    s_lshl_b32 s33, s21, 3
    s_add_u32 s33, s33, s22
    s_mul_i32 s33, s33, 20480
    s_mul_i32 s28, s20, 2560
    s_add_u32 s33, s33, s28
    s_add_u32 s33, s33, 393216
    buffer_load_dwordx4 v[192:195], v1, s[8:11], s33 offen sc1
    buffer_load_dwordx4 v[192:195], v1, s[8:11], s33 offen offset:1024 sc1
    buffer_load_dwordx4 v[192:195], v1, s[8:11], s33 offen offset:1536 sc1
    s_branch L_loop
L_pf1:
    s_add_u32 s33, s27, 16384
    buffer_load_dwordx4 v[192:195], v1, s[8:11], s33 offen offset:0 sc1
    buffer_load_dwordx4 v[196:199], v1, s[8:11], s33 offen offset:1024 sc1
    buffer_load_dwordx4 v[200:203], v1, s[8:11], s33 offen offset:2048 sc1
    buffer_load_dwordx4 v[204:207], v1, s[8:11], s33 offen offset:3072 sc1
    s_add_u32 s33, s27, 20480
    buffer_load_dwordx4 v[208:211], v1, s[8:11], s33 offen offset:0 sc1
    buffer_load_dwordx4 v[212:215], v1, s[8:11], s33 offen offset:1024 sc1
    buffer_load_dwordx4 v[216:219], v1, s[8:11], s33 offen offset:2048 sc1
    buffer_load_dwordx4 v[220:223], v1, s[8:11], s33 offen offset:3072 sc1
    s_add_u32 s33, s27, 24576
    buffer_load_dwordx4 v[168:171], v1, s[8:11], s33 offen offset:0 sc1
    s_branch L_loop
L_pf2:
    s_add_u32 s33, s27, 0
    buffer_load_dwordx4 v[192:195], v1, s[8:11], s33 offen offset:0 sc1
    buffer_load_dwordx4 v[196:199], v1, s[8:11], s33 offen offset:1024 sc1
    buffer_load_dwordx4 v[200:203], v1, s[8:11], s33 offen offset:2048 sc1
    buffer_load_dwordx4 v[204:207], v1, s[8:11], s33 offen offset:3072 sc1
    s_add_u32 s33, s27, 4096
    buffer_load_dwordx4 v[208:211], v1, s[8:11], s33 offen offset:0 sc1
    buffer_load_dwordx4 v[212:215], v1, s[8:11], s33 offen offset:1024 sc1
    buffer_load_dwordx4 v[216:219], v1, s[8:11], s33 offen offset:2048 sc1
    buffer_load_dwordx4 v[220:223], v1, s[8:11], s33 offen offset:3072 sc1
    s_branch L_loop
L_pf3:
    s_add_u32 s33, s27, 8192
    buffer_load_dwordx4 v[224:227], v1, s[8:11], s33 offen offset:0 sc1
    buffer_load_dwordx4 v[228:231], v1, s[8:11], s33 offen offset:1024 sc1
    buffer_load_dwordx4 v[232:235], v1, s[8:11], s33 offen offset:2048 sc1
    buffer_load_dwordx4 v[236:239], v1, s[8:11], s33 offen offset:3072 sc1
    s_add_u32 s33, s27, 12288
    buffer_load_dwordx4 v[240:243], v1, s[8:11], s33 offen offset:0 sc1
    buffer_load_dwordx4 v[244:247], v1, s[8:11], s33 offen offset:1024 sc1
    buffer_load_dwordx4 v[248:251], v1, s[8:11], s33 offen offset:2048 sc1
    buffer_load_dwordx4 v[252:255], v1, s[8:11], s33 offen offset:3072 sc1
    s_branch L_loop
L_aslow:
    s_setprio 1
    s_barrier
    s_branch L_slow
L_bwave:
    ds_read_b64_tr_b16 v[228:229], v192 offset:20480
    ds_read_b64_tr_b16 v[230:231], v192 offset:20736
    ds_read_b64_tr_b16 v[212:213], v244 offset:20480
    ds_read_b64_tr_b16 v[214:215], v244 offset:20736
    ds_read_b64_tr_b16 v[232:233], v193 offset:20480
    ds_read_b64_tr_b16 v[234:235], v193 offset:20736
    ds_read_b64_tr_b16 v[216:217], v245 offset:20480
    ds_read_b64_tr_b16 v[218:219], v245 offset:20736
    ds_read_b64_tr_b16 v[236:237], v194 offset:20480
    ds_read_b64_tr_b16 v[238:239], v194 offset:20736
    ds_read_b64_tr_b16 v[220:221], v246 offset:20480
    ds_read_b64_tr_b16 v[222:223], v246 offset:20736
    s_waitcnt lgkmcnt(6)
    ds_read_b64_tr_b16 v[240:241], v195 offset:20480
    ds_read_b64_tr_b16 v[242:243], v195 offset:20736
    ds_read_b64_tr_b16 v[224:225], v247 offset:20480
    ds_read_b64_tr_b16 v[226:227], v247 offset:20736
    s_waitcnt vmcnt(0) lgkmcnt(0)
    s_barrier
    s_cmp_eq_u32 s20, 4
    s_cbranch_scc1 L_rpl
    s_sub_u32 s33, s20, 5
    s_lshl_b32 s33, s33, 10
    s_add_u32 s33, s33, 40960
L_dma:
    s_mov_b32 m0, s33
    s_add_u32 s34, s33, s3
    s_cmp_ge_u32 s34, 163840
    s_cselect_b32 s28, 163840, 0
    s_sub_u32 s34, s34, s28
    s_add_u32 s34, s34, s26
    buffer_load_dwordx4 v1, s[8:11], s34 offen sc1 lds
    s_add_u32 s33, s33, 3072
    s_cmp_lt_u32 s33, 153600
    s_cbranch_scc1 L_dma
L_rplb:
    s_setprio 3
    v_mfma_f32_32x32x16_bf16 v[16:31], v[156:159], v[112:115], v[16:31]
    s_waitcnt vmcnt(63)
    v_max3_f32 v12, v12, v13, v14
    v_max_f32 v12, v12, v15
    v_mfma_f32_16x16x32_bf16 v[32:35], v[196:199], v[112:115], v[32:35]
    s_nop 1
    v_max_f32_dpp v12, v12, v12 row_ror:8 row_mask:0xf bank_mask:0xf
    s_nop 1
    v_mfma_f32_32x32x16_bf16 v[16:31], v[160:163], v[116:119], v[16:31]
    v_max_f32_dpp v12, v12, v12 row_ror:4 row_mask:0xf bank_mask:0xf
    s_nop 1
    v_max_f32_dpp v12, v12, v12 row_ror:2 row_mask:0xf bank_mask:0xf
    v_mfma_f32_16x16x32_bf16 v[32:35], v[200:203], v[116:119], v[32:35]
    s_nop 1
    v_max_f32_dpp v12, v12, v12 row_ror:1 row_mask:0xf bank_mask:0xf
    v_mov_b32 v13, v12
    v_mfma_f32_32x32x16_bf16 v[16:31], v[164:167], v[120:123], v[16:31]
    s_nop 1
    v_permlane16_swap_b32 v12, v13
    v_max_f32 v12, v12, v13
    v_mfma_f32_16x16x32_bf16 v[32:35], v[204:207], v[120:123], v[32:35]
    v_mov_b32 v13, v12
    s_nop 1
    v_permlane32_swap_b32 v12, v13
    v_mfma_f32_32x32x16_bf16 v[16:31], v[168:171], v[124:127], v[16:31]
    v_add_f32 v12, v12, v13
    v_sqrt_f32 v12, v12
    s_nop 0
    v_mfma_f32_16x16x32_bf16 v[32:35], v[208:211], v[124:127], v[32:35]
    v_mul_f32 v12, 0xbf8147ae, v12
    s_branch L_tJ
L_bw2:
    s_cmp_eq_u32 s20, 4
    s_cbranch_scc1 L_repack
    s_waitcnt vmcnt(0)
L_bsync:
    s_setprio 3
    s_barrier
    s_cmp_lg_u64 vcc, 0
    s_cbranch_scc1 L_slow
L_nosync:
    s_mov_b32 s35, 33248
    s_mov_b32 s32, 5
    s_branch L_go
L_rpl:
    s_cmp_eq_u32 s52, 1
    s_cbranch_scc1 L_rpa
    v_mov_b32 v5, 1
    v_mov_b32 v6, 0
    s_lshl_b32 s33, s23, 7
    s_mov_b64 exec, 1
    buffer_atomic_add v5, v6, s[72:75], s33 offen
    s_mov_b64 exec, -1
L_rpa:
    s_cmp_lt_u32 s2, 128
    s_cselect_b32 s4, s44, s54
    s_cselect_b32 s5, s45, s55
    s_mov_b32 s6, 819200
    s_mov_b32 s7, 0x00020000
    s_bfe_u32 s33, s2, 0x20005
    s_mul_i32 s33, s33, 160
    s_and_b32 s34, s2, 3
    s_mul_i32 s34, s34, 40
    s_add_u32 s33, s33, s34
    s_mul_i32 s33, s33, 1280
    s_bfe_u32 s34, s2, 0x30002
    s_mul_i32 s34, s34, 160
    s_add_u32 s33, s33, s34
    v_add_u32 v5, 0, v2
    v_mul_u32_u24 v6, 52429, v5
    v_lshrrev_b32 v6, 19, v6
    v_mul_u32_u24 v6, 1120, v6
    v_lshl_add_u32 v6, v5, 4, v6
    s_mov_b32 m0, 153600
    s_nop 0
    buffer_load_dwordx4 v6, s[4:7], s33 offen lds
    v_add_u32 v5, 64, v2
    v_mul_u32_u24 v6, 52429, v5
    v_lshrrev_b32 v6, 19, v6
    v_mul_u32_u24 v6, 1120, v6
    v_lshl_add_u32 v6, v5, 4, v6
    s_mov_b32 m0, 154624
    s_nop 0
    buffer_load_dwordx4 v6, s[4:7], s33 offen lds
    v_add_u32 v5, 128, v2
    v_mul_u32_u24 v6, 52429, v5
    v_lshrrev_b32 v6, 19, v6
    v_mul_u32_u24 v6, 1120, v6
    v_lshl_add_u32 v6, v5, 4, v6
    s_mov_b32 m0, 155648
    s_nop 0
    buffer_load_dwordx4 v6, s[4:7], s33 offen lds
    v_add_u32 v5, 192, v2
    v_mul_u32_u24 v6, 52429, v5
    v_lshrrev_b32 v6, 19, v6
    v_mul_u32_u24 v6, 1120, v6
    v_lshl_add_u32 v6, v5, 4, v6
    s_mov_b32 m0, 156672
    s_nop 0
    buffer_load_dwordx4 v6, s[4:7], s33 offen lds
    v_add_u32 v5, 256, v2
    v_mul_u32_u24 v6, 52429, v5
    v_lshrrev_b32 v6, 19, v6
    v_mul_u32_u24 v6, 1120, v6
    v_lshl_add_u32 v6, v5, 4, v6
    s_mov_b32 m0, 157696
    s_nop 0
    buffer_load_dwordx4 v6, s[4:7], s33 offen lds
    v_add_u32 v5, 320, v2
    v_mul_u32_u24 v6, 52429, v5
    v_lshrrev_b32 v6, 19, v6
    v_mul_u32_u24 v6, 1120, v6
    v_lshl_add_u32 v6, v5, 4, v6
    s_mov_b32 m0, 158720
    s_nop 0
    buffer_load_dwordx4 v6, s[4:7], s33 offen lds
    v_add_u32 v5, 384, v2
    v_mul_u32_u24 v6, 52429, v5
    v_lshrrev_b32 v6, 19, v6
    v_mul_u32_u24 v6, 1120, v6
    v_lshl_add_u32 v6, v5, 4, v6
    s_mov_b32 m0, 159744
    s_nop 0
    buffer_load_dwordx4 v6, s[4:7], s33 offen lds
    s_branch L_rplb
L_repack:
    v_and_b32 v6, 15, v2
    v_lshrrev_b32 v7, 4, v2
    v_and_b32 v8, 3, v6
    v_lshlrev_b32 v8, 3, v8
    v_lshrrev_b32 v9, 2, v6
    v_mul_u32_u24 v9, 160, v9
    s_mov_b32 s33, 153600
    v_add3_u32 v8, v8, v9, s33
    v_lshrrev_b32 v9, 1, v7
    v_mul_u32_u24 v9, 3200, v9
    v_and_b32 v11, 1, v7
    v_mul_u32_u24 v11, 640, v11
    v_add3_u32 v9, v9, v11, v8
    v_lshl_add_u32 v11, v7, 5, v8
    v_lshlrev_b32 v13, 4, v6
    v_lshl_add_u32 v13, v7, 10, v13
    s_waitcnt vmcnt(0) lgkmcnt(0)
    ds_read_b64_tr_b16 v[224:225], v9 offset:0
    ds_read_b64_tr_b16 v[226:227], v9 offset:1280
    ds_read_b64_tr_b16 v[228:229], v9 offset:32
    ds_read_b64_tr_b16 v[230:231], v9 offset:1312
    ds_read_b64_tr_b16 v[232:233], v9 offset:64
    ds_read_b64_tr_b16 v[234:235], v9 offset:1344
    ds_read_b64_tr_b16 v[236:237], v9 offset:96
    ds_read_b64_tr_b16 v[238:239], v9 offset:1376
    ds_read_b64_tr_b16 v[240:241], v9 offset:128
    ds_read_b64_tr_b16 v[242:243], v9 offset:1408
    ds_read_b64_tr_b16 v[244:245], v11 offset:2560
    ds_read_b64_tr_b16 v[246:247], v11 offset:5760
    ds_read_b64_tr_b16 v[248:249], v8 offset:2688
    ds_read_b64_tr_b16 v[250:251], v8 offset:5888
    s_bfe_u32 s4, s2, 0x30002
    s_lshl_b32 s5, s4, 3
    s_lshr_b32 s6, s2, 5
    s_add_u32 s5, s5, s6
    s_mul_i32 s5, s5, 25600
    s_add_u32 s5, s5, 5636096
    s_and_b32 s6, s2, 3
    s_mul_i32 s7, s6, 5120
    s_add_u32 s7, s7, s5
    s_lshl_b32 s6, s6, 8
    s_add_u32 s5, s5, s6
    s_add_u32 s5, s5, 20480
    s_add_u32 s6, s7, 4096
    s_waitcnt lgkmcnt(0)
    buffer_store_dwordx4 v[224:227], v1, s[8:11], s7 offen offset:0 sc1
    buffer_store_dwordx4 v[228:231], v1, s[8:11], s7 offen offset:1024 sc1
    buffer_store_dwordx4 v[232:235], v1, s[8:11], s7 offen offset:2048 sc1
    buffer_store_dwordx4 v[236:239], v1, s[8:11], s7 offen offset:3072 sc1
    buffer_store_dwordx4 v[240:243], v1, s[8:11], s6 offen sc1
    buffer_store_dwordx4 v[244:247], v13, s[8:11], s5 offen sc1
    s_add_u32 s5, s5, 4096
    s_mov_b64 exec, 0xffff
    buffer_store_dwordx4 v[248:251], v13, s[8:11], s5 offen sc1
    s_mov_b64 exec, -1
    s_mov_b32 s33, 153600
L_dma4:
    s_mov_b32 m0, s33
    s_add_u32 s34, s33, s3
    s_cmp_ge_u32 s34, 163840
    s_cselect_b32 s28, 163840, 0
    s_sub_u32 s34, s34, s28
    s_add_u32 s34, s34, s26
    buffer_load_dwordx4 v1, s[8:11], s34 offen sc1 lds
    s_add_u32 s33, s33, 1024
    s_cmp_lt_u32 s33, 163840
    s_cbranch_scc1 L_dma4
    s_lshl_b32 s4, s4, 2
    s_add_u32 s4, s4, 32
    v_mov_b32 v5, 1
    v_mov_b32 v6, 0
    s_waitcnt vmcnt(0)
    s_mov_b64 exec, 1
    buffer_atomic_add v5, v6, s[72:75], s4 offen
    s_mov_b64 exec, -1
    s_branch L_bsync
L_slow:
    v_mov_b32 v48, 0xff800000
    v_mov_b32 v49, 0xff800000
    v_mov_b32 v52, v188
    s_mov_b32 s34, 0
L_sl_loop:
    ds_read_b128 v[164:167], v52 offset:4096
    ds_read_b128 v[156:159], v52 offset:0
    s_waitcnt lgkmcnt(0)
    v_mfma_f32_32x32x4_2b_bf16 v[16:47], v[164:165], v[152:153], 0 cbsz:1 abid:0
    s_nop 15
    s_nop 1
    v_mfma_f32_32x32x16_bf16 v[16:31], v[156:159], v[144:147], v[16:31]
    v_mfma_f32_32x32x16_bf16 v[32:47], v[156:159], v[148:151], v[32:47]
    s_nop 11
    v_max3_f32 v48, v16, v17, v48
    v_max3_f32 v48, v18, v19, v48
    v_max3_f32 v48, v20, v21, v48
    v_max3_f32 v48, v22, v23, v48
    v_max3_f32 v48, v24, v25, v48
    v_max3_f32 v48, v26, v27, v48
    v_max3_f32 v48, v28, v29, v48
    v_max3_f32 v48, v30, v31, v48
    v_max3_f32 v49, v32, v33, v49
    v_max3_f32 v49, v34, v35, v49
    v_max3_f32 v49, v36, v37, v49
    v_max3_f32 v49, v38, v39, v49
    v_max3_f32 v49, v40, v41, v49
    v_max3_f32 v49, v42, v43, v49
    v_max3_f32 v49, v44, v45, v49
    v_max3_f32 v49, v46, v47, v49
    ds_read_b128 v[156:159], v52 offset:1024
    s_waitcnt lgkmcnt(0)
    v_mfma_f32_32x32x4_2b_bf16 v[16:47], v[164:165], v[152:153], 0 cbsz:1 abid:1
    s_nop 15
    s_nop 1
    v_mfma_f32_32x32x16_bf16 v[16:31], v[156:159], v[144:147], v[16:31]
    v_mfma_f32_32x32x16_bf16 v[32:47], v[156:159], v[148:151], v[32:47]
    s_nop 11
    v_max3_f32 v48, v16, v17, v48
    v_max3_f32 v48, v18, v19, v48
    v_max3_f32 v48, v20, v21, v48
    v_max3_f32 v48, v22, v23, v48
    v_max3_f32 v48, v24, v25, v48
    v_max3_f32 v48, v26, v27, v48
    v_max3_f32 v48, v28, v29, v48
    v_max3_f32 v48, v30, v31, v48
    v_max3_f32 v49, v32, v33, v49
    v_max3_f32 v49, v34, v35, v49
    v_max3_f32 v49, v36, v37, v49
    v_max3_f32 v49, v38, v39, v49
    v_max3_f32 v49, v40, v41, v49
    v_max3_f32 v49, v42, v43, v49
    v_max3_f32 v49, v44, v45, v49
    v_max3_f32 v49, v46, v47, v49
    ds_read_b128 v[156:159], v52 offset:2048
    s_waitcnt lgkmcnt(0)
    v_mfma_f32_32x32x4_2b_bf16 v[16:47], v[166:167], v[152:153], 0 cbsz:1 abid:0
    s_nop 15
    s_nop 1
    v_mfma_f32_32x32x16_bf16 v[16:31], v[156:159], v[144:147], v[16:31]
    v_mfma_f32_32x32x16_bf16 v[32:47], v[156:159], v[148:151], v[32:47]
    s_nop 11
    v_max3_f32 v48, v16, v17, v48
    v_max3_f32 v48, v18, v19, v48
    v_max3_f32 v48, v20, v21, v48
    v_max3_f32 v48, v22, v23, v48
    v_max3_f32 v48, v24, v25, v48
    v_max3_f32 v48, v26, v27, v48
    v_max3_f32 v48, v28, v29, v48
    v_max3_f32 v48, v30, v31, v48
    v_max3_f32 v49, v32, v33, v49
    v_max3_f32 v49, v34, v35, v49
    v_max3_f32 v49, v36, v37, v49
    v_max3_f32 v49, v38, v39, v49
    v_max3_f32 v49, v40, v41, v49
    v_max3_f32 v49, v42, v43, v49
    v_max3_f32 v49, v44, v45, v49
    v_max3_f32 v49, v46, v47, v49
    ds_read_b128 v[156:159], v52 offset:3072
    s_waitcnt lgkmcnt(0)
    v_mfma_f32_32x32x4_2b_bf16 v[16:47], v[166:167], v[152:153], 0 cbsz:1 abid:1
    s_nop 15
    s_nop 1
    v_mfma_f32_32x32x16_bf16 v[16:31], v[156:159], v[144:147], v[16:31]
    v_mfma_f32_32x32x16_bf16 v[32:47], v[156:159], v[148:151], v[32:47]
    s_nop 11
    v_max3_f32 v48, v16, v17, v48
    v_max3_f32 v48, v18, v19, v48
    v_max3_f32 v48, v20, v21, v48
    v_max3_f32 v48, v22, v23, v48
    v_max3_f32 v48, v24, v25, v48
    v_max3_f32 v48, v26, v27, v48
    v_max3_f32 v48, v28, v29, v48
    v_max3_f32 v48, v30, v31, v48
    v_max3_f32 v49, v32, v33, v49
    v_max3_f32 v49, v34, v35, v49
    v_max3_f32 v49, v36, v37, v49
    v_max3_f32 v49, v38, v39, v49
    v_max3_f32 v49, v40, v41, v49
    v_max3_f32 v49, v42, v43, v49
    v_max3_f32 v49, v44, v45, v49
    v_max3_f32 v49, v46, v47, v49
    v_add_u32 v52, s29, v52
    s_add_u32 s34, s34, 1
    s_cmp_lt_u32 s34, 16
    s_cbranch_scc1 L_sl_loop
    v_mov_b32 v50, v48
    v_mov_b32 v51, v49
    s_nop 1
    v_permlane32_swap_b32 v48, v50
    v_permlane32_swap_b32 v49, v51
    s_nop 1
    v_max_f32 v48, v48, v50
    v_max_f32 v49, v49, v51
    v_sub_f32 v48, 0, v48
    v_sub_f32 v49, 0, v49
    ds_read_b128 v[156:159], v188 offset:0
    ds_read_b128 v[160:163], v188 offset:1024
    ds_read_b128 v[164:167], v188 offset:4096
    s_mov_b64 exec, s[30:31]
    ds_read_b128 v[172:175], v189 offset:5120
    ds_read_b128 v[176:179], v189 offset:5760
    s_mov_b64 exec, -1
    s_branch L_nosync
L_codeend:
.section .rodata,"a"
.p2align 6
.amdhsa_kernel gated_mix__grouped_kv_mqa__grouped_kv_mqa__prompt_kernel
  .amdhsa_next_free_vgpr 256
  .amdhsa_next_free_sgpr 102
  .amdhsa_accum_offset 256
  .amdhsa_group_segment_fixed_size 0
  .amdhsa_kernarg_size 112
  .amdhsa_user_sgpr_count 2
  .amdhsa_user_sgpr_kernarg_segment_ptr 1
  .amdhsa_system_sgpr_workgroup_id_x 1
.end_amdhsa_kernel
```
